```python
import torch

def _softmax(x, axis=-1):
    return torch.softmax(x, dim=axis)
def _gelu(x):
    return torch.nn.functional.gelu(x, approximate="tanh")
def _silu(x):
    return torch.nn.functional.silu(x)
def _sigmoid(x):
    return torch.sigmoid(x)
def _layernorm(x, axis=-1, eps=1e-5):
    m = x.mean(dim=axis, keepdim=True)
    v = x.var(dim=axis, keepdim=True, unbiased=False)
    return (x - m) / torch.sqrt(v + eps)
def _scatter_add(tgt, idx, src, axis=0):
    return tgt.clone().index_add_(axis, idx, src)
def _segment_sum(src, seg, n):
    out = torch.zeros((n,) + src.shape[1:], dtype=src.dtype)
    return out.index_add_(0, seg, src)
def _pad(x, pw):
    flat = tuple(v for pair in reversed(pw) for v in pair)
    return torch.nn.functional.pad(x, flat)

kernel_name = 'concat_heads__mha_block_cached__gqa_block_cached__near_ridge'

def setup_inputs():

    _w = (lambda a: (lambda t: t.to(torch.bfloat16) if t.is_floating_point() else t)(torch.as_tensor(a)))
    def _A_setup():
        B, Sq, D = 16, 96, 448
        H, Sk, Dh = 16, 96, 256
        return {
            "x": _w((lambda *s: torch.randn(*s, dtype=torch.bfloat16) * 0.8)(B, Sq, D)),
            "k_cache": _w((lambda *s: torch.randn(*s, dtype=torch.bfloat16) * 0.8)(B, H, Sk, Dh)),
            "v_cache": _w((lambda *s: torch.randn(*s, dtype=torch.bfloat16) * 0.05)(B, H, Sk, Dh)),
            "wq": _w((lambda *s: torch.randn(*s, dtype=torch.bfloat16) * 0.8)(D, H * Dh) * (D ** -0.5)),
            "wo": _w((lambda *s: torch.randn(*s, dtype=torch.bfloat16) * 0.05)(H * Dh, D) * ((H * Dh) ** -0.5)),
        }
    _A_in = _A_setup()

    def _B_setup():
        B, Sq, D = 16, 96, 448
        Hq, Hkv, Sk, Dh = 16, 16, 96, 256
        assert Hq % Hkv == 0, (Hq, Hkv)
        return {
            "x": _w((lambda *s: torch.randn(*s, dtype=torch.bfloat16) * 0.8)(B, Sq, D)),
            "k_cache": _w((lambda *s: torch.randn(*s, dtype=torch.bfloat16) * 0.8)(B, Hkv, Sk, Dh)),
            "v_cache": _w((lambda *s: torch.randn(*s, dtype=torch.bfloat16) * 0.05)(B, Hkv, Sk, Dh)),
            "wq": _w((lambda *s: torch.randn(*s, dtype=torch.bfloat16) * 0.8)(D, Hq * Dh) * (D ** -0.5)),
            "wo": _w((lambda *s: torch.randn(*s, dtype=torch.bfloat16) * 0.05)(Hq * Dh, D) * ((Hq * Dh) ** -0.5)),
        }
    _B_in = _B_setup()

    return {
        "A_x": _A_in["x"],
        "A_k_cache": _A_in["k_cache"],
        "A_v_cache": _A_in["v_cache"],
        "A_wq": _A_in["wq"],
        "A_wo": _A_in["wo"],
        "B_x": _B_in["x"],
        "B_k_cache": _B_in["k_cache"],
        "B_v_cache": _B_in["v_cache"],
        "B_wq": _B_in["wq"],
        "B_wo": _B_in["wo"],
    }

def reference(A_x, A_k_cache, A_v_cache, A_wq, A_wo, B_x, B_k_cache, B_v_cache, B_wq, B_wo):
    def _A_ref(x, k_cache, v_cache, wq, wo):
        B, Sq, D = x.shape
        H, Dh = 16, 256
        q = (lambda x, *d: x.permute(*d))((x @ wq).reshape(B, Sq, H, Dh), 0, 2, 1, 3)
        scores = torch.einsum("bhqd,bhkd->bhqk", q, k_cache) * (Dh ** -0.5)
        p = _softmax(scores, axis=-1)
        o = torch.einsum("bhqk,bhkd->bhqd", p, v_cache)
        return (lambda x, *d: x.permute(*d))(o, 0, 2, 1, 3).reshape(B, Sq, H * Dh) @ wo

    def _B_ref(x, k_cache, v_cache, wq, wo):
        B, Sq, D = x.shape
        Hq, Dh = 16, 256
        Hkv = k_cache.shape[1]
        rep = Hq // Hkv
        q = (lambda x, *d: x.permute(*d))((x @ wq).reshape(B, Sq, Hq, Dh), 0, 2, 1, 3)
        k = (lambda x, n, axis: torch.repeat_interleave(x, n, dim=axis))(k_cache, rep, axis=1)
        v = (lambda x, n, axis: torch.repeat_interleave(x, n, dim=axis))(v_cache, rep, axis=1)
        scores = torch.einsum("bhqd,bhkd->bhqk", q, k) * (Dh ** -0.5)
        p = _softmax(scores, axis=-1)
        o = torch.einsum("bhqk,bhkd->bhqd", p, v)
        return (lambda x, *d: x.permute(*d))(o, 0, 2, 1, 3).reshape(B, Sq, Hq * Dh) @ wo

    a = _A_ref(A_x, A_k_cache, A_v_cache, A_wq, A_wo)
    b = _B_ref(B_x, B_k_cache, B_v_cache, B_wq, B_wo)
    return torch.concatenate([a, b], axis=-1)
```

```asm
; @launch grid=(256,1,1) block=(512,1,1) lds=163840
.amdgcn_target "amdgcn-amd-amdhsa--gfx950"
.text
.globl concat_heads__mha_block_cached__gqa_block_cached__near_ridge_kernel
.p2align 8
.type concat_heads__mha_block_cached__gqa_block_cached__near_ridge_kernel,@function
concat_heads__mha_block_cached__gqa_block_cached__near_ridge_kernel:
    s_bfe_u32 s38, s2, 0x10002
    s_mul_i32 s4, s38, 40
    s_cmp_ge_u32 s2, 256
    s_cbranch_scc1 L_end
    s_load_dwordx2 s[44:45], s[0:1], s4
    s_load_dwordx2 s[56:57], s[0:1], s4 offset:24
    s_load_dwordx2 s[48:49], s[0:1], s4 offset:8
    s_load_dwordx2 s[52:53], s[0:1], s4 offset:16
    s_load_dwordx2 s[60:61], s[0:1], s4 offset:32
    s_load_dwordx2 s[64:65], s[0:1], 96
    s_load_dwordx2 s[32:33], s[0:1], 80
    s_load_dwordx2 s[24:25], s[0:1], 88
    v_lshrrev_b32 v1, 6, v0
    v_and_b32 v0, 63, v0
    v_readfirstlane_b32 s3, v1
    s_lshr_b32 s42, s2, 3
    s_and_b32 s39, s2, 3
    s_lshl_b32 s39, s39, 1
    s_and_b32 s43, s42, 1
    s_or_b32 s39, s39, s43
    s_lshr_b32 s40, s42, 1
    s_lshl_b32 s36, s38, 4
    s_add_u32 s36, s36, s40
    s_mov_b32 s37, 200000
    s_mov_b32 s66, 134217728
    s_mov_b32 s67, 0x20000
    s_mov_b32 s26, 256
    s_mov_b32 s27, 0x20000
    s_cmp_lt_u32 s3, 4
    s_cbranch_scc0 L_L
    s_getpc_b64 s[8:9]
L_pc:
    s_lshl_b32 s4, s42, 2
    s_add_u32 s4, s4, s3
    s_lshl_b32 s4, s4, 9
    v_min_u32 v7, 7, v0
    v_lshl_add_u32 v7, v7, 6, s4
    v_min_u32 v7, L_end-L_pc, v7
    global_load_dword v7, v7, s[8:9]
    s_waitcnt vmcnt(0)
    s_branch L_C
L_L:
    s_sub_u32 s68, s3, 4
    s_lshr_b32 s69, s68, 1
    s_and_b32 s28, s68, 1
    s_mov_b32 s46, 1376256
    s_mov_b32 s47, 0x20000
    s_mov_b32 s58, 3670016
    s_mov_b32 s59, 0x20000
    v_lshrrev_b32 v10, 3, v0
    v_mul_u32_u24 v5, 896, v10
    v_bfe_u32 v10, v0, 4, 2
    v_lshlrev_b32 v10, 1, v10
    v_and_b32 v11, 7, v0
    v_xor_b32 v10, v10, v11
    v_lshl_add_u32 v5, v10, 4, v5
    v_add_u32 v6, 6144, v5
    v_add_u32 v7, 12288, v5
    v_add_u32 v8, 18432, v5
    s_mul_i32 s17, s40, 86016
    s_mul_i32 s5, s68, 21504
    s_add_u32 s9, s17, s5
    s_mul_i32 s10, s68, 3072
    s_add_u32 s10, s10, 65536
    v_lshlrev_b32 v12, 4, v0
    s_lshl_b32 s18, s40, 2
    s_add_u32 s18, s18, s68
    s_lshl_b32 s18, s18, 13
    s_lshl_b32 s4, s39, 10
    s_add_u32 s18, s18, s4
    v_mul_u32_u24 v13, 896, v0
    v_cmp_gt_u32 vcc, 12, v0
    v_mov_b32 v14, 0x7f000000
    s_nop 0
    v_cndmask_b32 v13, v14, v13, vcc
    s_mul_i32 s19, s43, 43008
    s_mul_i32 s5, s68, 10752
    s_add_u32 s19, s19, s5
    s_add_u32 s19, s19, s17
    v_bfe_u32 v10, v0, 3, 2
    v_bfe_u32 v11, v0, 5, 1
    v_lshl_or_b32 v10, v11, 3, v10
    v_mul_u32_u24 v1, 8192, v10
    v_bfe_u32 v10, v0, 4, 2
    v_lshlrev_b32 v10, 1, v10
    v_and_b32 v11, 7, v0
    v_xor_b32 v10, v10, v11
    v_lshl_add_u32 v1, v10, 4, v1
    v_add_u32 v2, 130048, v1
    v_add_u32 v3, 30720, v1
    v_add_u32 v4, 160768, v1
    s_lshl_b32 s5, s69, 9
    s_add_u32 s4, s4, s5
    s_lshl_b32 s5, s28, 7
    s_add_u32 s4, s4, s5
    s_lshl_b32 s8, s68, 12
    s_waitcnt lgkmcnt(0)
    s_add_u32 s5, s18, 0
    buffer_load_dwordx4 v[140:143], v12, s[56:59], s5 offen
    s_add_u32 m0, s10, 0
    s_add_u32 s5, s9, 0
    buffer_load_dwordx4 v5, s[44:47], s5 offen offset:0 lds
    buffer_load_dwordx4 v6, s[44:47], s5 offen offset:1024 lds
    buffer_load_dwordx4 v7, s[44:47], s5 offen offset:2048 lds
    s_add_u32 m0, s8, 0
    s_add_u32 s5, s4, 0
    buffer_load_dwordx4 v1, s[56:59], s5 offen offset:0 lds
    buffer_load_dwordx4 v2, s[56:59], s5 offen offset:1024 lds
    buffer_load_dwordx4 v3, s[56:59], s5 offen offset:2048 lds
    buffer_load_dwordx4 v4, s[56:59], s5 offen offset:3072 lds
    s_add_u32 s5, s18, 524288
    buffer_load_dwordx4 v[140:143], v12, s[56:59], s5 offen
    buffer_load_dword v144, v13, s[44:47], s19 offen offset:128
    s_mov_b32 s50, 12582912
    s_mov_b32 s51, 0x20000
    s_mov_b32 s54, 12582912
    s_mov_b32 s55, 0x20000
    s_mov_b32 s62, 3670016
    s_mov_b32 s63, 0x20000
    s_mov_b32 s34, 2752512
    s_mov_b32 s35, 0x20000
    s_memrealtime s[30:31]
    s_or_b32 s5, s39, s68
    v_or_b32 v10, s5, v0
    v_min_u32 v10, 1, v10
    v_lshlrev_b32 v10, 30, v10
    s_lshl_b32 s21, s36, 3
    s_waitcnt lgkmcnt(0)
    s_or_b32 s31, s31, 0x80000000
    v_mov_b32 v152, s30
    v_mov_b32 v153, s31
    buffer_store_dwordx2 v[152:153], v10, s[24:27], s21 offen sc1
    v_lshrrev_b32 v10, 3, v0
    v_mul_u32_u24 v9, 512, v10
    v_bfe_u32 v10, v0, 4, 1
    v_bfe_u32 v11, v0, 5, 1
    v_lshl_or_b32 v10, v11, 2, v10
    v_and_b32 v11, 7, v0
    v_xor_b32 v10, v10, v11
    v_lshl_add_u32 v9, v10, 4, v9
    s_lshl_b32 s14, s40, 4
    s_lshl_b32 s5, s39, 1
    s_add_u32 s14, s14, s5
    s_add_u32 s14, s14, s69
    s_mul_i32 s14, s14, 49152
    s_mul_i32 s5, s28, 24576
    s_add_u32 s14, s14, s5
    s_mul_i32 s20, s69, 12288
    s_mul_i32 s5, s28, 6144
    s_add_u32 s20, s20, s5
    s_add_u32 s20, s20, 65536
    v_bfe_u32 v15, v0, 3, 2
    v_lshlrev_b32 v15, 9, v15
    v_lshrrev_b32 v10, 5, v0
    v_lshl_or_b32 v15, v10, 7, v15
    v_and_b32 v10, 7, v0
    v_lshl_or_b32 v15, v10, 4, v15
    s_mul_i32 s12, s39, 458752
    s_mul_i32 s5, s69, 229376
    s_add_u32 s12, s12, s5
    s_mul_i32 s5, s28, 28672
    s_add_u32 s12, s12, s5
    s_mov_b32 s16, s12
    s_add_u32 s5, s39, 1
    s_sub_u32 s7, s39, 6
    s_cmp_ge_u32 s39, 6
    s_cselect_b32 s5, s7, s5
    s_lshl_b32 s41, s5, 7
    s_add_u32 s12, s12, s41
    v_mov_b32 v156, 0
    v_add_u32 v148, s20, v12
    v_bfe_u32 v10, v0, 3, 2
    v_lshlrev_b32 v149, 7, v10
    v_bfe_u32 v10, v0, 4, 1
    v_lshlrev_b32 v10, 1, v10
    v_and_b32 v11, 7, v0
    v_xor_b32 v10, v10, v11
    v_lshl_or_b32 v149, v10, 4, v149
    v_lshrrev_b32 v10, 5, v0
    v_mul_u32_u24 v10, 12288, v10
    v_add_u32 v149, v149, v10
    s_mul_i32 s5, s69, 24576
    s_mul_i32 s7, s28, 6144
    s_add_u32 s5, s5, s7
    s_add_u32 s5, s5, 65536
    v_add_u32 v149, s5, v149
    v_xor_b32 v150, 64, v149
    v_add_u32 v150, 512, v150
    s_mul_i32 s5, s39, 458752
    s_mul_i32 s7, s40, 28672
    s_add_u32 s5, s5, s7
    s_mul_i32 s7, s68, 7168
    s_add_u32 s5, s5, s7
    s_add_u32 s42, s60, s5
    s_addc_u32 s43, s61, 0
    s_add_u32 m0, s8, 16384
    s_add_u32 s5, s4, 256
    buffer_load_dwordx4 v1, s[56:59], s5 offen offset:0 lds
    buffer_load_dwordx4 v2, s[56:59], s5 offen offset:1024 lds
    buffer_load_dwordx4 v3, s[56:59], s5 offen offset:2048 lds
    buffer_load_dwordx4 v4, s[56:59], s5 offen offset:3072 lds
    s_add_u32 m0, s8, 32768
    s_add_u32 s5, s4, 262144
    buffer_load_dwordx4 v1, s[56:59], s5 offen offset:0 lds
    buffer_load_dwordx4 v2, s[56:59], s5 offen offset:1024 lds
    buffer_load_dwordx4 v3, s[56:59], s5 offen offset:2048 lds
    buffer_load_dwordx4 v4, s[56:59], s5 offen offset:3072 lds
    s_waitcnt vmcnt(11)
    s_barrier
    s_add_u32 m0, s8, 49152
    s_add_u32 s5, s4, 262400
    buffer_load_dwordx4 v1, s[56:59], s5 offen offset:0 lds
    buffer_load_dwordx4 v2, s[56:59], s5 offen offset:1024 lds
    buffer_load_dwordx4 v3, s[56:59], s5 offen offset:2048 lds
    buffer_load_dwordx4 v4, s[56:59], s5 offen offset:3072 lds
    s_add_u32 m0, s10, 12288
    s_add_u32 s5, s9, 128
    buffer_load_dwordx4 v5, s[44:47], s5 offen offset:0 lds
    buffer_load_dwordx4 v6, s[44:47], s5 offen offset:1024 lds
    buffer_load_dwordx4 v7, s[44:47], s5 offen offset:2048 lds
    s_add_u32 s5, s18, 1048576
    buffer_load_dwordx4 v[140:143], v12, s[56:59], s5 offen
    buffer_load_dword v144, v13, s[44:47], s19 offen offset:256
    buffer_load_dword v144, v13, s[44:47], s19 offen offset:384
    s_add_u32 s5, s14, 0
    s_add_u32 m0, s20, 24576
    s_nop 0
    buffer_load_dwordx4 v9, s[48:51], s5 offen offset:0 nt lds
    s_add_u32 s5, s14, 0
    s_add_u32 m0, s20, 49024
    s_nop 0
    buffer_load_dwordx4 v9, s[48:51], s5 offen offset:128 nt lds
    s_waitcnt vmcnt(16)
    s_barrier
    s_waitcnt vmcnt(12)
    s_barrier
    s_add_u32 m0, s8, 0
    s_add_u32 s5, s4, 524288
    buffer_load_dwordx4 v1, s[56:59], s5 offen offset:0 lds
    buffer_load_dwordx4 v2, s[56:59], s5 offen offset:1024 lds
    buffer_load_dwordx4 v3, s[56:59], s5 offen offset:2048 lds
    buffer_load_dwordx4 v4, s[56:59], s5 offen offset:3072 lds
    s_add_u32 m0, s8, 16384
    s_add_u32 s5, s4, 524544
    buffer_load_dwordx4 v1, s[56:59], s5 offen offset:0 lds
    buffer_load_dwordx4 v2, s[56:59], s5 offen offset:1024 lds
    buffer_load_dwordx4 v3, s[56:59], s5 offen offset:2048 lds
    buffer_load_dwordx4 v4, s[56:59], s5 offen offset:3072 lds
    s_waitcnt vmcnt(16)
    s_barrier
    s_add_u32 m0, s8, 32768
    s_add_u32 s5, s4, 786432
    buffer_load_dwordx4 v1, s[56:59], s5 offen offset:0 lds
    buffer_load_dwordx4 v2, s[56:59], s5 offen offset:1024 lds
    buffer_load_dwordx4 v3, s[56:59], s5 offen offset:2048 lds
    buffer_load_dwordx4 v4, s[56:59], s5 offen offset:3072 lds
    s_add_u32 m0, s10, 0
    s_add_u32 s5, s9, 256
    buffer_load_dwordx4 v5, s[44:47], s5 offen offset:0 lds
    buffer_load_dwordx4 v6, s[44:47], s5 offen offset:1024 lds
    buffer_load_dwordx4 v7, s[44:47], s5 offen offset:2048 lds
    s_waitcnt vmcnt(11)
    s_barrier
    s_add_u32 m0, s8, 49152
    s_add_u32 s5, s4, 786688
    buffer_load_dwordx4 v1, s[56:59], s5 offen offset:0 lds
    buffer_load_dwordx4 v2, s[56:59], s5 offen offset:1024 lds
    buffer_load_dwordx4 v3, s[56:59], s5 offen offset:2048 lds
    buffer_load_dwordx4 v4, s[56:59], s5 offen offset:3072 lds
    s_waitcnt vmcnt(11)
    s_barrier
    s_add_u32 m0, s8, 0
    s_add_u32 s5, s4, 1048576
    buffer_load_dwordx4 v1, s[56:59], s5 offen offset:0 lds
    buffer_load_dwordx4 v2, s[56:59], s5 offen offset:1024 lds
    buffer_load_dwordx4 v3, s[56:59], s5 offen offset:2048 lds
    buffer_load_dwordx4 v4, s[56:59], s5 offen offset:3072 lds
    s_add_u32 s5, s18, 1572864
    buffer_load_dwordx4 v[140:143], v12, s[56:59], s5 offen
    s_add_u32 s5, s18, 2097152
    buffer_load_dwordx4 v[140:143], v12, s[56:59], s5 offen
    buffer_load_dword v144, v13, s[44:47], s19 offen offset:512
    s_add_u32 s5, s14, 4096
    s_add_u32 m0, s20, 25600
    s_nop 0
    buffer_load_dwordx4 v9, s[48:51], s5 offen offset:0 nt lds
    s_add_u32 s5, s14, 4096
    s_add_u32 m0, s20, 50048
    s_nop 0
    buffer_load_dwordx4 v9, s[48:51], s5 offen offset:128 nt lds
    s_add_u32 s5, s14, 8192
    s_add_u32 m0, s20, 26624
    s_nop 0
    buffer_load_dwordx4 v9, s[48:51], s5 offen offset:0 nt lds
    s_waitcnt vmcnt(17)
    s_barrier
    s_waitcnt vmcnt(10)
    s_barrier
    s_add_u32 m0, s8, 16384
    s_add_u32 s5, s4, 1048832
    buffer_load_dwordx4 v1, s[56:59], s5 offen offset:0 lds
    buffer_load_dwordx4 v2, s[56:59], s5 offen offset:1024 lds
    buffer_load_dwordx4 v3, s[56:59], s5 offen offset:2048 lds
    buffer_load_dwordx4 v4, s[56:59], s5 offen offset:3072 lds
    s_add_u32 m0, s8, 32768
    s_add_u32 s5, s4, 1310720
    buffer_load_dwordx4 v1, s[56:59], s5 offen offset:0 lds
    buffer_load_dwordx4 v2, s[56:59], s5 offen offset:1024 lds
    buffer_load_dwordx4 v3, s[56:59], s5 offen offset:2048 lds
    buffer_load_dwordx4 v4, s[56:59], s5 offen offset:3072 lds
    s_add_u32 m0, s10, 12288
    s_add_u32 s5, s9, 384
    buffer_load_dwordx4 v5, s[44:47], s5 offen offset:0 lds
    buffer_load_dwordx4 v6, s[44:47], s5 offen offset:1024 lds
    buffer_load_dwordx4 v7, s[44:47], s5 offen offset:2048 lds
    s_waitcnt vmcnt(17)
    s_barrier
    s_add_u32 m0, s8, 49152
    s_add_u32 s5, s4, 1310976
    buffer_load_dwordx4 v1, s[56:59], s5 offen offset:0 lds
    buffer_load_dwordx4 v2, s[56:59], s5 offen offset:1024 lds
    buffer_load_dwordx4 v3, s[56:59], s5 offen offset:2048 lds
    buffer_load_dwordx4 v4, s[56:59], s5 offen offset:3072 lds
    s_waitcnt vmcnt(11)
    s_barrier
    s_add_u32 m0, s8, 0
    s_add_u32 s5, s4, 1572864
    buffer_load_dwordx4 v1, s[56:59], s5 offen offset:0 lds
    buffer_load_dwordx4 v2, s[56:59], s5 offen offset:1024 lds
    buffer_load_dwordx4 v3, s[56:59], s5 offen offset:2048 lds
    buffer_load_dwordx4 v4, s[56:59], s5 offen offset:3072 lds
    s_waitcnt vmcnt(11)
    s_barrier
    s_add_u32 m0, s8, 16384
    s_add_u32 s5, s4, 1573120
    buffer_load_dwordx4 v1, s[56:59], s5 offen offset:0 lds
    buffer_load_dwordx4 v2, s[56:59], s5 offen offset:1024 lds
    buffer_load_dwordx4 v3, s[56:59], s5 offen offset:2048 lds
    buffer_load_dwordx4 v4, s[56:59], s5 offen offset:3072 lds
    s_add_u32 s5, s18, 2621440
    buffer_load_dwordx4 v[140:143], v12, s[56:59], s5 offen
    buffer_load_dword v144, v13, s[44:47], s19 offen offset:640
    s_add_u32 s5, s14, 8192
    s_add_u32 m0, s20, 51072
    s_nop 0
    buffer_load_dwordx4 v9, s[48:51], s5 offen offset:128 nt lds
    s_add_u32 s5, s14, 12288
    s_add_u32 m0, s20, 27648
    s_nop 0
    buffer_load_dwordx4 v9, s[48:51], s5 offen offset:0 nt lds
    s_add_u32 s5, s14, 12288
    s_add_u32 m0, s20, 52096
    s_nop 0
    buffer_load_dwordx4 v9, s[48:51], s5 offen offset:128 nt lds
    s_add_u32 s5, s14, 16384
    s_add_u32 m0, s20, 28672
    s_nop 0
    buffer_load_dwordx4 v9, s[48:51], s5 offen offset:0 nt lds
    s_waitcnt vmcnt(14)
    s_barrier
    s_waitcnt vmcnt(10)
    s_barrier
    s_add_u32 m0, s8, 32768
    s_add_u32 s5, s4, 1835008
    buffer_load_dwordx4 v1, s[56:59], s5 offen offset:0 lds
    buffer_load_dwordx4 v2, s[56:59], s5 offen offset:1024 lds
    buffer_load_dwordx4 v3, s[56:59], s5 offen offset:2048 lds
    buffer_load_dwordx4 v4, s[56:59], s5 offen offset:3072 lds
    s_add_u32 m0, s8, 49152
    s_add_u32 s5, s4, 1835264
    buffer_load_dwordx4 v1, s[56:59], s5 offen offset:0 lds
    buffer_load_dwordx4 v2, s[56:59], s5 offen offset:1024 lds
    buffer_load_dwordx4 v3, s[56:59], s5 offen offset:2048 lds
    buffer_load_dwordx4 v4, s[56:59], s5 offen offset:3072 lds
    s_add_u32 m0, s10, 0
    s_add_u32 s5, s9, 512
    buffer_load_dwordx4 v5, s[44:47], s5 offen offset:0 lds
    buffer_load_dwordx4 v6, s[44:47], s5 offen offset:1024 lds
    buffer_load_dwordx4 v7, s[44:47], s5 offen offset:2048 lds
    s_waitcnt vmcnt(17)
    s_barrier
    s_add_u32 m0, s8, 0
    s_add_u32 s5, s4, 2097152
    buffer_load_dwordx4 v1, s[56:59], s5 offen offset:0 lds
    buffer_load_dwordx4 v2, s[56:59], s5 offen offset:1024 lds
    buffer_load_dwordx4 v3, s[56:59], s5 offen offset:2048 lds
    buffer_load_dwordx4 v4, s[56:59], s5 offen offset:3072 lds
    s_waitcnt vmcnt(11)
    s_barrier
    s_add_u32 m0, s8, 16384
    s_add_u32 s5, s4, 2097408
    buffer_load_dwordx4 v1, s[56:59], s5 offen offset:0 lds
    buffer_load_dwordx4 v2, s[56:59], s5 offen offset:1024 lds
    buffer_load_dwordx4 v3, s[56:59], s5 offen offset:2048 lds
    buffer_load_dwordx4 v4, s[56:59], s5 offen offset:3072 lds
    s_waitcnt vmcnt(11)
    s_barrier
    s_add_u32 m0, s8, 32768
    s_add_u32 s5, s4, 2359296
    buffer_load_dwordx4 v1, s[56:59], s5 offen offset:0 lds
    buffer_load_dwordx4 v2, s[56:59], s5 offen offset:1024 lds
    buffer_load_dwordx4 v3, s[56:59], s5 offen offset:2048 lds
    buffer_load_dwordx4 v4, s[56:59], s5 offen offset:3072 lds
    s_add_u32 m0, s10, 12288
    s_add_u32 s5, s9, 640
    buffer_load_dwordx4 v5, s[44:47], s5 offen offset:0 lds
    buffer_load_dwordx4 v6, s[44:47], s5 offen offset:1024 lds
    buffer_load_dwordx4 v7, s[44:47], s5 offen offset:2048 lds
    s_add_u32 s5, s18, 3145728
    buffer_load_dwordx4 v[140:143], v12, s[56:59], s5 offen
    buffer_load_dword v144, v13, s[44:47], s19 offen offset:768
    s_add_u32 s5, s14, 16384
    s_add_u32 m0, s20, 53120
    s_nop 0
    buffer_load_dwordx4 v9, s[48:51], s5 offen offset:128 nt lds
    s_add_u32 s5, s14, 20480
    s_add_u32 m0, s20, 29696
    s_nop 0
    buffer_load_dwordx4 v9, s[48:51], s5 offen offset:0 nt lds
    s_add_u32 s5, s14, 20480
    s_add_u32 m0, s20, 54144
    s_nop 0
    buffer_load_dwordx4 v9, s[48:51], s5 offen offset:128 nt lds
    s_add_u32 s5, s14, 0
    s_add_u32 m0, s20, 73472
    s_nop 0
    buffer_load_dwordx4 v9, s[48:51], s5 offen offset:256 nt lds
    s_waitcnt vmcnt(17)
    s_barrier
    s_waitcnt vmcnt(13)
    s_barrier
    s_add_u32 m0, s8, 49152
    s_add_u32 s5, s4, 2359552
    buffer_load_dwordx4 v1, s[56:59], s5 offen offset:0 lds
    buffer_load_dwordx4 v2, s[56:59], s5 offen offset:1024 lds
    buffer_load_dwordx4 v3, s[56:59], s5 offen offset:2048 lds
    buffer_load_dwordx4 v4, s[56:59], s5 offen offset:3072 lds
    s_add_u32 m0, s8, 0
    s_add_u32 s5, s4, 2621440
    buffer_load_dwordx4 v1, s[56:59], s5 offen offset:0 lds
    buffer_load_dwordx4 v2, s[56:59], s5 offen offset:1024 lds
    buffer_load_dwordx4 v3, s[56:59], s5 offen offset:2048 lds
    buffer_load_dwordx4 v4, s[56:59], s5 offen offset:3072 lds
    s_waitcnt vmcnt(17)
    s_barrier
    s_add_u32 m0, s8, 16384
    s_add_u32 s5, s4, 2621696
    buffer_load_dwordx4 v1, s[56:59], s5 offen offset:0 lds
    buffer_load_dwordx4 v2, s[56:59], s5 offen offset:1024 lds
    buffer_load_dwordx4 v3, s[56:59], s5 offen offset:2048 lds
    buffer_load_dwordx4 v4, s[56:59], s5 offen offset:3072 lds
    s_waitcnt vmcnt(8)
    s_barrier
    s_add_u32 m0, s8, 32768
    s_add_u32 s5, s4, 2883584
    buffer_load_dwordx4 v1, s[56:59], s5 offen offset:0 lds
    buffer_load_dwordx4 v2, s[56:59], s5 offen offset:1024 lds
    buffer_load_dwordx4 v3, s[56:59], s5 offen offset:2048 lds
    buffer_load_dwordx4 v4, s[56:59], s5 offen offset:3072 lds
    s_add_u32 m0, s10, 0
    s_add_u32 s5, s9, 768
    buffer_load_dwordx4 v5, s[44:47], s5 offen offset:0 lds
    buffer_load_dwordx4 v6, s[44:47], s5 offen offset:1024 lds
    buffer_load_dwordx4 v7, s[44:47], s5 offen offset:2048 lds
    s_waitcnt vmcnt(11)
    s_barrier
    s_add_u32 m0, s8, 49152
    s_add_u32 s5, s4, 2883840
    buffer_load_dwordx4 v1, s[56:59], s5 offen offset:0 lds
    buffer_load_dwordx4 v2, s[56:59], s5 offen offset:1024 lds
    buffer_load_dwordx4 v3, s[56:59], s5 offen offset:2048 lds
    buffer_load_dwordx4 v4, s[56:59], s5 offen offset:3072 lds
    s_add_u32 s5, s14, 4096
    s_add_u32 m0, s20, 74496
    s_nop 0
    buffer_load_dwordx4 v9, s[48:51], s5 offen offset:256 nt lds
    s_add_u32 s5, s14, 8192
    s_add_u32 m0, s20, 75520
    s_nop 0
    buffer_load_dwordx4 v9, s[48:51], s5 offen offset:256 nt lds
    s_add_u32 s5, s14, 12288
    s_add_u32 m0, s20, 76544
    s_nop 0
    buffer_load_dwordx4 v9, s[48:51], s5 offen offset:256 nt lds
    s_add_u32 s5, s14, 16384
    s_add_u32 m0, s20, 77568
    s_nop 0
    buffer_load_dwordx4 v9, s[48:51], s5 offen offset:256 nt lds
    s_add_u32 s5, s14, 20480
    s_add_u32 m0, s20, 78592
    s_nop 0
    buffer_load_dwordx4 v9, s[48:51], s5 offen offset:256 nt lds
    s_add_u32 s5, s14, 0
    buffer_load_dwordx4 v[16:19], v9, s[48:51], s5 offen offset:384 nt
    s_add_u32 s5, s14, 4096
    buffer_load_dwordx4 v[20:23], v9, s[48:51], s5 offen offset:384 nt
    s_waitcnt vmcnt(18)
    s_barrier
    s_waitcnt vmcnt(14)
    s_barrier
    s_add_u32 m0, s8, 0
    s_add_u32 s5, s4, 3145728
    buffer_load_dwordx4 v1, s[56:59], s5 offen offset:0 lds
    buffer_load_dwordx4 v2, s[56:59], s5 offen offset:1024 lds
    buffer_load_dwordx4 v3, s[56:59], s5 offen offset:2048 lds
    buffer_load_dwordx4 v4, s[56:59], s5 offen offset:3072 lds
    s_add_u32 m0, s8, 16384
    s_add_u32 s5, s4, 3145984
    buffer_load_dwordx4 v1, s[56:59], s5 offen offset:0 lds
    buffer_load_dwordx4 v2, s[56:59], s5 offen offset:1024 lds
    buffer_load_dwordx4 v3, s[56:59], s5 offen offset:2048 lds
    buffer_load_dwordx4 v4, s[56:59], s5 offen offset:3072 lds
    s_waitcnt vmcnt(15)
    s_barrier
    s_add_u32 m0, s8, 32768
    s_add_u32 s5, s4, 3407872
    buffer_load_dwordx4 v1, s[56:59], s5 offen offset:0 lds
    buffer_load_dwordx4 v2, s[56:59], s5 offen offset:1024 lds
    buffer_load_dwordx4 v3, s[56:59], s5 offen offset:2048 lds
    buffer_load_dwordx4 v4, s[56:59], s5 offen offset:3072 lds
    s_waitcnt vmcnt(8)
    s_barrier
    s_add_u32 m0, s8, 49152
    s_add_u32 s5, s4, 3408128
    buffer_load_dwordx4 v1, s[56:59], s5 offen offset:0 lds
    buffer_load_dwordx4 v2, s[56:59], s5 offen offset:1024 lds
    buffer_load_dwordx4 v3, s[56:59], s5 offen offset:2048 lds
    buffer_load_dwordx4 v4, s[56:59], s5 offen offset:3072 lds
    s_add_u32 s5, s14, 8192
    buffer_load_dwordx4 v[24:27], v9, s[48:51], s5 offen offset:384 nt
    s_add_u32 s5, s14, 12288
    buffer_load_dwordx4 v[28:31], v9, s[48:51], s5 offen offset:384 nt
    s_add_u32 s5, s14, 16384
    buffer_load_dwordx4 v[32:35], v9, s[48:51], s5 offen offset:384 nt
    s_add_u32 s5, s14, 20480
    buffer_load_dwordx4 v[36:39], v9, s[48:51], s5 offen offset:384 nt
    s_add_u32 s5, s14, 0
    buffer_load_dwordx4 v[40:43], v15, s[52:55], s5 offen offset:0 nt
    s_add_u32 s5, s14, 0
    buffer_load_dwordx4 v[44:47], v15, s[52:55], s5 offen offset:2048 nt
    s_add_u32 s5, s14, 4096
    buffer_load_dwordx4 v[48:51], v15, s[52:55], s5 offen offset:0 nt
    s_waitcnt vmcnt(15)
    s_barrier
    s_waitcnt vmcnt(11)
    s_barrier
    s_waitcnt vmcnt(7)
    s_barrier
    s_add_u32 s5, s14, 4096
    buffer_load_dwordx4 v[52:55], v15, s[52:55], s5 offen offset:2048 nt
    s_add_u32 s5, s14, 8192
    buffer_load_dwordx4 v[56:59], v15, s[52:55], s5 offen offset:0 nt
    s_add_u32 s5, s14, 8192
    buffer_load_dwordx4 v[60:63], v15, s[52:55], s5 offen offset:2048 nt
    s_barrier
    s_add_u32 s5, s14, 12288
    buffer_load_dwordx4 v[64:67], v15, s[52:55], s5 offen offset:0 nt
    s_add_u32 s5, s14, 12288
    buffer_load_dwordx4 v[68:71], v15, s[52:55], s5 offen offset:2048 nt
    s_add_u32 s5, s14, 16384
    buffer_load_dwordx4 v[72:75], v15, s[52:55], s5 offen offset:0 nt
    s_add_u32 s5, s14, 16384
    buffer_load_dwordx4 v[76:79], v15, s[52:55], s5 offen offset:2048 nt
    s_add_u32 s5, s14, 20480
    buffer_load_dwordx4 v[80:83], v15, s[52:55], s5 offen offset:0 nt
    buffer_load_dwordx2 v[152:153], v156, s[24:27], s21 offen sc1
    ds_write_b128 v148, v[16:19] offset:0
    ds_write_b128 v148, v[20:23] offset:1024
    s_waitcnt vmcnt(15)
    ds_write_b128 v148, v[24:27] offset:2048
    s_waitcnt vmcnt(14)
    ds_write_b128 v148, v[28:31] offset:3072
    s_waitcnt vmcnt(13)
    ds_write_b128 v148, v[32:35] offset:4096
    s_waitcnt vmcnt(12)
    ds_write_b128 v148, v[36:39] offset:5120
    s_add_u32 s5, s14, 20480
    buffer_load_dwordx4 v[84:87], v15, s[52:55], s5 offen offset:2048 nt
    s_lshl_b32 s5, s28, 13
    s_add_u32 s14, s14, s5
    s_add_u32 s5, s14, 0
    buffer_load_dwordx4 v[88:91], v15, s[52:55], s5 offen offset:256 nt
    s_waitcnt lgkmcnt(0)
    s_barrier
    s_add_u32 s5, s14, 0
    buffer_load_dwordx4 v[92:95], v15, s[52:55], s5 offen offset:2304 nt
    s_add_u32 s5, s14, 4096
    buffer_load_dwordx4 v[96:99], v15, s[52:55], s5 offen offset:256 nt
    s_add_u32 s5, s14, 4096
    buffer_load_dwordx4 v[100:103], v15, s[52:55], s5 offen offset:2304 nt
    s_barrier
    s_add_u32 s5, s14, 8192
    buffer_load_dwordx4 v[104:107], v15, s[52:55], s5 offen offset:256 nt
    s_add_u32 s5, s14, 8192
    buffer_load_dwordx4 v[108:111], v15, s[52:55], s5 offen offset:2304 nt
    s_add_u32 s5, s14, 12288
    buffer_load_dwordx4 v[112:115], v15, s[52:55], s5 offen offset:256 nt
    s_add_u32 s5, s14, 12288
    buffer_load_dwordx4 v[116:119], v15, s[52:55], s5 offen offset:2304 nt
    s_mul_i32 s5, s28, 24576
    s_sub_u32 s14, s14, s5
    s_add_u32 s5, s14, 16384
    buffer_load_dwordx4 v[120:123], v15, s[52:55], s5 offen offset:256 nt
    s_add_u32 s5, s14, 16384
    buffer_load_dwordx4 v[124:127], v15, s[52:55], s5 offen offset:2304 nt
    s_add_u32 s5, s14, 20480
    buffer_load_dwordx4 v[128:131], v15, s[52:55], s5 offen offset:256 nt
    s_add_u32 s5, s14, 20480
    buffer_load_dwordx4 v[132:135], v15, s[52:55], s5 offen offset:2304 nt
    v_lshlrev_b32 v10, 7, v0
    s_mul_i32 s5, s39, 458752
    s_mul_i32 s7, s40, 28672
    s_add_u32 s5, s5, s7
    s_mul_i32 s7, s68, 7168
    s_add_u32 s5, s5, s7
    buffer_load_dword v144, v10, s[60:63], s5 offen
    s_waitcnt vmcnt(24)
    ds_write_b128 v149, v[40:43] offset:49152
    ds_write_b128 v150, v[44:47] offset:49152
    s_waitcnt vmcnt(22)
    ds_write_b128 v149, v[48:51] offset:50176
    ds_write_b128 v150, v[52:55] offset:50176
    s_waitcnt vmcnt(20)
    ds_write_b128 v149, v[56:59] offset:51200
    ds_write_b128 v150, v[60:63] offset:51200
    s_waitcnt vmcnt(18)
    ds_write_b128 v149, v[64:67] offset:52224
    ds_write_b128 v150, v[68:71] offset:52224
    s_waitcnt vmcnt(16)
    ds_write_b128 v149, v[72:75] offset:53248
    ds_write_b128 v150, v[76:79] offset:53248
    s_waitcnt vmcnt(13)
    ds_write_b128 v149, v[80:83] offset:54272
    ds_write_b128 v150, v[84:87] offset:54272
    s_lshl_b32 s5, s28, 11
    v_add_u32 v149, s5, v149
    v_add_u32 v150, s5, v150
    s_waitcnt vmcnt(11)
    ds_write_b128 v149, v[88:91] offset:0
    ds_write_b128 v150, v[92:95] offset:0
    s_waitcnt vmcnt(9)
    ds_write_b128 v149, v[96:99] offset:1024
    ds_write_b128 v150, v[100:103] offset:1024
    v_cmp_eq_u32 vcc, 0, v153
    s_cbranch_vccnz L_nsl
L_nbk:
    s_waitcnt lgkmcnt(0)
    s_barrier
    s_waitcnt vmcnt(7)
    ds_write_b128 v149, v[104:107] offset:2048
    ds_write_b128 v150, v[108:111] offset:2048
    s_waitcnt vmcnt(5)
    ds_write_b128 v149, v[112:115] offset:3072
    ds_write_b128 v150, v[116:119] offset:3072
    s_waitcnt lgkmcnt(0)
    s_barrier
    s_mul_i32 s5, s28, 6144
    v_subrev_u32 v149, s5, v149
    v_subrev_u32 v150, s5, v150
    s_add_u32 m0, s8, 0
    s_add_u32 s5, s12, 0
    buffer_load_dwordx4 v5, s[60:63], s5 offen offset:0 lds
    buffer_load_dwordx4 v6, s[60:63], s5 offen offset:1024 lds
    s_waitcnt vmcnt(5)
    ds_write_b128 v149, v[120:123] offset:4096
    ds_write_b128 v150, v[124:127] offset:4096
    s_add_u32 m0, s8, 0
    s_add_u32 s5, s12, 0
    buffer_load_dwordx4 v7, s[60:63], s5 offen offset:2048 lds
    buffer_load_dwordx4 v8, s[60:63], s5 offen offset:3072 lds
    s_waitcnt vmcnt(5)
    ds_write_b128 v149, v[128:131] offset:5120
    ds_write_b128 v150, v[132:135] offset:5120
    s_add_u32 m0, s8, 16384
    s_add_u32 s5, s12, 57344
    buffer_load_dwordx4 v5, s[60:63], s5 offen offset:0 lds
    buffer_load_dwordx4 v6, s[60:63], s5 offen offset:1024 lds
    s_waitcnt lgkmcnt(0)
    s_barrier
    s_add_u32 m0, s8, 16384
    s_add_u32 s5, s12, 57344
    buffer_load_dwordx4 v7, s[60:63], s5 offen offset:2048 lds
    buffer_load_dwordx4 v8, s[60:63], s5 offen offset:3072 lds
    s_add_u32 m0, s8, 32768
    s_add_u32 s5, s12, 114688
    buffer_load_dwordx4 v5, s[60:63], s5 offen offset:0 lds
    buffer_load_dwordx4 v6, s[60:63], s5 offen offset:1024 lds
    buffer_load_dwordx4 v7, s[60:63], s5 offen offset:2048 lds
    buffer_load_dwordx4 v8, s[60:63], s5 offen offset:3072 lds
    s_add_u32 m0, s8, 49152
    s_add_u32 s5, s12, 172032
    buffer_load_dwordx4 v5, s[60:63], s5 offen offset:0 lds
    buffer_load_dwordx4 v6, s[60:63], s5 offen offset:1024 lds
    buffer_load_dwordx4 v7, s[60:63], s5 offen offset:2048 lds
    buffer_load_dwordx4 v8, s[60:63], s5 offen offset:3072 lds
    s_add_u32 s12, s12, 128
    s_sub_u32 s5, s12, 896
    s_cmp_eq_u32 s5, s16
    s_cselect_b32 s12, s5, s12
    v_readfirstlane_b32 s14, v152
    v_min_u32 v9, 1, v0
    v_lshlrev_b32 v9, 30, v9
    s_lshl_b32 s9, s36, 5
    s_add_u32 s9, s9, s68
    s_lshl_b32 s9, s9, 8
    s_add_u32 s9, s9, 31457280
    s_lshl_b32 s5, s39, 10
    s_add_u32 s13, s9, s5
    s_waitcnt vmcnt(8)
    s_barrier
    s_add_u32 m0, s8, 147456
    s_add_u32 s5, s12, 0
    buffer_load_dwordx4 v5, s[60:63], s5 offen offset:0 lds
    buffer_load_dwordx4 v6, s[60:63], s5 offen offset:1024 lds
    buffer_load_dwordx4 v7, s[60:63], s5 offen offset:2048 lds
    buffer_load_dwordx4 v8, s[60:63], s5 offen offset:3072 lds
    s_add_u32 m0, s8, 131072
    s_add_u32 s5, s12, 57344
    buffer_load_dwordx4 v5, s[60:63], s5 offen offset:0 lds
    buffer_load_dwordx4 v6, s[60:63], s5 offen offset:1024 lds
    buffer_load_dwordx4 v7, s[60:63], s5 offen offset:2048 lds
    buffer_load_dwordx4 v8, s[60:63], s5 offen offset:3072 lds
    s_mul_i32 s17, s36, 917504
    s_add_u32 s17, s17, 0
    s_lshl_b32 s5, s68, 12
    s_add_u32 s17, s17, s5
    s_mov_b32 s7, s39
    s_mov_b32 s51, 0
    s_sub_u32 s7, s7, 1
    s_cselect_b32 s7, 6, s7
    s_lshl_b32 s5, s7, 14
    s_add_u32 s50, s17, s5
    s_add_u32 s50, s50, 802816
    s_mul_i32 s5, s7, 114688
    s_add_u32 s5, s5, 0
    s_add_u32 s44, s17, s5
    s_sub_u32 s7, s7, 1
    s_cselect_b32 s7, 6, s7
    s_mul_i32 s5, s7, 114688
    s_add_u32 s5, s5, 16384
    s_add_u32 s45, s17, s5
    s_sub_u32 s7, s7, 1
    s_cselect_b32 s7, 6, s7
    s_mul_i32 s5, s7, 114688
    s_add_u32 s5, s5, 32768
    s_add_u32 s46, s17, s5
    s_sub_u32 s7, s7, 1
    s_cselect_b32 s7, 6, s7
    s_mul_i32 s5, s7, 114688
    s_add_u32 s5, s5, 49152
    s_add_u32 s47, s17, s5
    s_sub_u32 s7, s7, 1
    s_cselect_b32 s7, 6, s7
    s_bitset1_b32 s51, s7
    s_mul_i32 s5, s7, 114688
    s_add_u32 s5, s5, 65536
    s_add_u32 s48, s17, s5
    s_sub_u32 s7, s7, 1
    s_cselect_b32 s7, 6, s7
    s_bitset1_b32 s51, s7
    s_mul_i32 s5, s7, 114688
    s_add_u32 s5, s5, 81920
    s_add_u32 s49, s17, s5
    s_waitcnt vmcnt(8)
    s_barrier
    s_add_u32 m0, s8, 114688
    s_add_u32 s5, s12, 114688
    buffer_load_dwordx4 v5, s[60:63], s5 offen offset:0 lds
    buffer_load_dwordx4 v6, s[60:63], s5 offen offset:1024 lds
    buffer_load_dwordx4 v7, s[60:63], s5 offen offset:2048 lds
    buffer_load_dwordx4 v8, s[60:63], s5 offen offset:3072 lds
    s_add_u32 m0, s8, 98304
    s_add_u32 s5, s12, 172032
    buffer_load_dwordx4 v5, s[60:63], s5 offen offset:0 lds
    buffer_load_dwordx4 v6, s[60:63], s5 offen offset:1024 lds
    buffer_load_dwordx4 v7, s[60:63], s5 offen offset:2048 lds
    buffer_load_dwordx4 v8, s[60:63], s5 offen offset:3072 lds
    s_add_u32 s12, s12, 128
    s_sub_u32 s5, s12, 896
    s_cmp_eq_u32 s5, s16
    s_cselect_b32 s12, s5, s12
    s_mov_b32 s11, 0xffff0000
    s_mov_b32 s7, 0x07060302
    s_cmp_gt_u32 s39, 3
    s_cselect_b32 s5, 128, 0
    s_or_b32 s51, s51, s5
    s_mov_b32 vcc_lo, s51
    s_mov_b32 vcc_hi, 0
    v_lshlrev_b32 v2, 10, v0
    v_mov_b32 v3, 2.0
    v_cndmask_b32 v2, v3, v2, vcc
    v_and_b32 v3, 15, v0
    v_mul_u32_u24 v3, 1792, v3
    v_bfe_u32 v4, v0, 4, 1
    v_lshl_add_u32 v3, v4, 5, v3
    v_lshrrev_b32 v4, 5, v0
    v_lshl_add_u32 v3, v4, 4, v3
    s_mul_i32 s10, s40, 96
    s_mul_i32 s5, s28, 48
    s_add_u32 s10, s10, s5
    s_mul_i32 s10, s10, 1792
    s_mul_i32 s5, s38, 896
    s_add_u32 s10, s10, s5
    s_lshl_b32 s5, s39, 7
    s_add_u32 s10, s10, s5
    s_lshl_b32 s5, s69, 6
    s_add_u32 s10, s10, s5
    s_xor_b32 s5, s68, 2
    s_mul_i32 s5, s5, 6400
    s_add_u32 s5, s5, 98304
    v_lshl_add_u32 v10, v0, 2, s5
    s_mul_i32 s5, s68, 6144
    s_add_u32 s5, s5, 131072
    v_add_u32 v11, s5, v12
    v_mov_b32 v160, 0
    v_mov_b32 v161, 0
    v_mov_b32 v162, 0
    v_mov_b32 v163, 0
    v_mov_b32 v164, 0
    v_mov_b32 v165, 0
    v_mov_b32 v166, 0
    v_mov_b32 v167, 0
    v_mov_b32 v168, 0
    v_mov_b32 v169, 0
    v_mov_b32 v170, 0
    v_mov_b32 v171, 0
    v_mov_b32 v172, 0
    v_mov_b32 v173, 0
    v_mov_b32 v174, 0
    v_mov_b32 v175, 0
    v_mov_b32 v176, 0
    v_mov_b32 v177, 0
    v_mov_b32 v178, 0
    v_mov_b32 v179, 0
    v_mov_b32 v180, 0
    v_mov_b32 v181, 0
    v_mov_b32 v182, 0
    v_mov_b32 v183, 0
    s_mul_i32 s14, s14, 0x9e3779b1
    s_lshr_b32 s4, s14, 15
    s_xor_b32 s14, s14, s4
    v_and_b32 v4, 3, v0
    v_lshlrev_b32 v4, 3, v4
    v_lshrrev_b32 v4, v4, s14
    v_and_b32 v4, 0xff, v4
    v_lshl_or_b32 v4, v4, 15, v4
    v_lshrrev_b32 v144, 0, v4
    v_lshrrev_b32 v145, 2, v4
    v_lshrrev_b32 v146, 4, v4
    v_lshrrev_b32 v147, 6, v4
    v_mov_b32 v148, 0x8000
    s_mov_b32 s6, 0x10001
    v_and_b32 v144, s6, v144
    v_and_b32 v145, s6, v145
    v_and_b32 v146, s6, v146
    v_and_b32 v147, s6, v147
    v_lshrrev_b32 v4, 4, v0
    v_bfe_u32 v128, v0, 2, 2
    v_cmp_eq_u32 vcc, v4, v128
    v_and_b32 v4, 1, v0
    v_lshlrev_b32 v4, 4, v4
    v_mov_b32 v132, 0x3f80
    v_lshlrev_b32 v4, v4, v132
    v_cndmask_b32 v4, 0, v4, vcc
    v_and_b32 v128, 2, v0
    v_cmp_eq_u32 vcc, 0, v128
    s_nop 1
    v_cndmask_b32 v130, 0, v4, vcc
    v_cndmask_b32 v131, v4, v156, vcc
    v_mov_b32 v128, 0
    v_mov_b32 v129, 0
    v_mov_b32 v132, 0
    v_mov_b32 v133, 0
    s_setprio 3
    s_waitcnt vmcnt(0)
    s_barrier
    s_add_u32 m0, s8, 0
    s_add_u32 s5, s12, 0
    buffer_load_dwordx4 v5, s[60:63], s5 offen offset:0 lds
    buffer_load_dwordx4 v6, s[60:63], s5 offen offset:1024 lds
    buffer_load_dwordx4 v7, s[60:63], s5 offen offset:2048 lds
    buffer_load_dwordx4 v8, s[60:63], s5 offen offset:3072 lds
    s_add_u32 m0, s8, 16384
    s_add_u32 s5, s12, 57344
    buffer_load_dwordx4 v5, s[60:63], s5 offen offset:0 lds
    buffer_load_dwordx4 v6, s[60:63], s5 offen offset:1024 lds
    s_add_u32 m0, s8, 16384
    s_add_u32 s5, s12, 57344
    buffer_load_dwordx4 v7, s[60:63], s5 offen offset:2048 lds
    buffer_load_dwordx4 v8, s[60:63], s5 offen offset:3072 lds
    s_add_u32 m0, s8, 32768
    s_add_u32 s5, s12, 114688
    buffer_load_dwordx4 v5, s[60:63], s5 offen offset:0 lds
    buffer_load_dwordx4 v6, s[60:63], s5 offen offset:1024 lds
    buffer_load_dwordx4 v7, s[60:63], s5 offen offset:2048 lds
    buffer_load_dwordx4 v8, s[60:63], s5 offen offset:3072 lds
    s_add_u32 m0, s8, 49152
    s_add_u32 s5, s12, 172032
    buffer_load_dwordx4 v5, s[60:63], s5 offen offset:0 lds
    buffer_load_dwordx4 v6, s[60:63], s5 offen offset:1024 lds
    buffer_load_dwordx4 v7, s[60:63], s5 offen offset:2048 lds
    buffer_load_dwordx4 v8, s[60:63], s5 offen offset:3072 lds
    s_add_u32 s12, s12, 128
    s_sub_u32 s5, s12, 896
    s_cmp_eq_u32 s5, s16
    s_cselect_b32 s12, s5, s12
    s_waitcnt vmcnt(0)
    s_barrier
    s_add_u32 m0, s8, 147456
    s_add_u32 s5, s12, 0
    buffer_load_dwordx4 v5, s[60:63], s5 offen offset:0 lds
    buffer_load_dwordx4 v6, s[60:63], s5 offen offset:1024 lds
    buffer_load_dwordx4 v7, s[60:63], s5 offen offset:2048 lds
    buffer_load_dwordx4 v8, s[60:63], s5 offen offset:3072 lds
    s_add_u32 m0, s8, 131072
    s_add_u32 s5, s12, 57344
    buffer_load_dwordx4 v5, s[60:63], s5 offen offset:0 lds
    buffer_load_dwordx4 v6, s[60:63], s5 offen offset:1024 lds
    s_add_u32 m0, s8, 131072
    s_add_u32 s5, s12, 57344
    buffer_load_dwordx4 v7, s[60:63], s5 offen offset:2048 lds
    buffer_load_dwordx4 v8, s[60:63], s5 offen offset:3072 lds
    s_add_u32 m0, s8, 114688
    s_add_u32 s5, s12, 114688
    buffer_load_dwordx4 v5, s[60:63], s5 offen offset:0 lds
    buffer_load_dwordx4 v6, s[60:63], s5 offen offset:1024 lds
    buffer_load_dwordx4 v7, s[60:63], s5 offen offset:2048 lds
    buffer_load_dwordx4 v8, s[60:63], s5 offen offset:3072 lds
    s_add_u32 m0, s8, 98304
    s_add_u32 s5, s12, 172032
    buffer_load_dwordx4 v5, s[60:63], s5 offen offset:0 lds
    buffer_load_dwordx4 v6, s[60:63], s5 offen offset:1024 lds
    buffer_load_dwordx4 v7, s[60:63], s5 offen offset:2048 lds
    buffer_load_dwordx4 v8, s[60:63], s5 offen offset:3072 lds
    s_add_u32 s12, s12, 128
    s_sub_u32 s5, s12, 896
    s_cmp_eq_u32 s5, s16
    s_cselect_b32 s12, s5, s12
    s_waitcnt vmcnt(0)
    s_barrier
    s_add_u32 m0, s8, 0
    s_add_u32 s5, s12, 0
    buffer_load_dwordx4 v5, s[60:63], s5 offen offset:0 lds
    buffer_load_dwordx4 v6, s[60:63], s5 offen offset:1024 lds
    buffer_load_dwordx4 v7, s[60:63], s5 offen offset:2048 lds
    buffer_load_dwordx4 v8, s[60:63], s5 offen offset:3072 lds
    s_add_u32 m0, s8, 16384
    s_add_u32 s5, s12, 57344
    buffer_load_dwordx4 v5, s[60:63], s5 offen offset:0 lds
    buffer_load_dwordx4 v6, s[60:63], s5 offen offset:1024 lds
    s_add_u32 m0, s8, 16384
    s_add_u32 s5, s12, 57344
    buffer_load_dwordx4 v7, s[60:63], s5 offen offset:2048 lds
    buffer_load_dwordx4 v8, s[60:63], s5 offen offset:3072 lds
    s_add_u32 m0, s8, 32768
    s_add_u32 s5, s12, 114688
    buffer_load_dwordx4 v5, s[60:63], s5 offen offset:0 lds
    buffer_load_dwordx4 v6, s[60:63], s5 offen offset:1024 lds
    buffer_load_dwordx4 v7, s[60:63], s5 offen offset:2048 lds
    buffer_load_dwordx4 v8, s[60:63], s5 offen offset:3072 lds
    s_add_u32 m0, s8, 49152
    s_add_u32 s5, s12, 172032
    buffer_load_dwordx4 v5, s[60:63], s5 offen offset:0 lds
    buffer_load_dwordx4 v6, s[60:63], s5 offen offset:1024 lds
    buffer_load_dwordx4 v7, s[60:63], s5 offen offset:2048 lds
    buffer_load_dwordx4 v8, s[60:63], s5 offen offset:3072 lds
    s_add_u32 s12, s12, 128
    s_sub_u32 s5, s12, 896
    s_cmp_eq_u32 s5, s16
    s_cselect_b32 s12, s5, s12
    s_cmp_eq_u32 s39, 7
    s_cbranch_scc1 L_cw
    s_waitcnt vmcnt(11)
    buffer_load_dwordx4 v[16:19], v12, s[64:67], s44 offen offset:0 sc1
    s_waitcnt vmcnt(11)
    buffer_load_dwordx4 v[20:23], v12, s[64:67], s44 offen offset:1024 sc1
    s_waitcnt vmcnt(11)
    buffer_load_dwordx4 v[24:27], v12, s[64:67], s44 offen offset:2048 sc1
    s_waitcnt vmcnt(3)
    s_barrier
    s_add_u32 m0, s8, 147456
    s_add_u32 s5, s12, 0
    buffer_load_dwordx4 v5, s[60:63], s5 offen offset:0 lds
    buffer_load_dwordx4 v6, s[60:63], s5 offen offset:1024 lds
    s_add_u32 m0, s8, 147456
    s_add_u32 s5, s12, 0
    buffer_load_dwordx4 v7, s[60:63], s5 offen offset:2048 lds
    buffer_load_dwordx4 v8, s[60:63], s5 offen offset:3072 lds
    s_add_u32 m0, s8, 131072
    s_add_u32 s5, s12, 57344
    buffer_load_dwordx4 v5, s[60:63], s5 offen offset:0 lds
    buffer_load_dwordx4 v6, s[60:63], s5 offen offset:1024 lds
    buffer_load_dwordx4 v7, s[60:63], s5 offen offset:2048 lds
    buffer_load_dwordx4 v8, s[60:63], s5 offen offset:3072 lds
    s_add_u32 m0, s8, 114688
    s_add_u32 s5, s12, 114688
    buffer_load_dwordx4 v5, s[60:63], s5 offen offset:0 lds
    buffer_load_dwordx4 v6, s[60:63], s5 offen offset:1024 lds
    buffer_load_dwordx4 v7, s[60:63], s5 offen offset:2048 lds
    buffer_load_dwordx4 v8, s[60:63], s5 offen offset:3072 lds
    s_add_u32 m0, s8, 98304
    s_add_u32 s5, s12, 172032
    buffer_load_dwordx4 v5, s[60:63], s5 offen offset:0 lds
    buffer_load_dwordx4 v6, s[60:63], s5 offen offset:1024 lds
    buffer_load_dwordx4 v7, s[60:63], s5 offen offset:2048 lds
    buffer_load_dwordx4 v8, s[60:63], s5 offen offset:3072 lds
    s_add_u32 s12, s12, 128
    s_sub_u32 s5, s12, 896
    s_cmp_eq_u32 s5, s16
    s_cselect_b32 s12, s5, s12
    s_waitcnt vmcnt(11)
    buffer_load_dwordx4 v[32:35], v12, s[64:67], s45 offen offset:0 sc1
    s_waitcnt vmcnt(11)
    buffer_load_dwordx4 v[36:39], v12, s[64:67], s45 offen offset:1024 sc1
    s_waitcnt vmcnt(11)
    buffer_load_dwordx4 v[40:43], v12, s[64:67], s45 offen offset:2048 sc1
L_yt0:
    v_bitop3_b32 v232, v16, v20, v144 bitop3:0x7e
    v_bitop3_b32 v233, v17, v21, v145 bitop3:0x7e
    v_bitop3_b32 v234, v18, v22, v146 bitop3:0x7e
    v_bitop3_b32 v235, v19, v23, v147 bitop3:0x7e
    v_bitop3_b32 v232, v232, v24, v144 bitop3:0xf6
    v_bitop3_b32 v233, v233, v25, v145 bitop3:0xf6
    v_bitop3_b32 v234, v234, v26, v146 bitop3:0xf6
    v_bitop3_b32 v235, v235, v27, v147 bitop3:0xf6
    v_or3_b32 v4, v232, v233, v234
    v_bitop3_b32 v4, v4, v235, s6 bitop3:0xa8
    v_cmp_ne_u32 vcc, 0, v4
    v_or_b32 v16, s6, v16
    v_or_b32 v17, s6, v17
    v_or_b32 v18, s6, v18
    v_or_b32 v19, s6, v19
    v_or_b32 v20, s6, v20
    v_or_b32 v21, s6, v21
    v_or_b32 v22, s6, v22
    v_or_b32 v23, s6, v23
    v_or_b32 v24, s6, v24
    v_or_b32 v25, s6, v25
    v_or_b32 v26, s6, v26
    v_or_b32 v27, s6, v27
    s_cbranch_vccnz L_yt0_r
    v_mfma_f32_16x16x32_bf16 v[160:163], v[130:133], v[16:19], v[160:163]
    v_mfma_f32_16x16x32_bf16 v[172:175], v[128:131], v[16:19], v[172:175]
    v_mfma_f32_16x16x32_bf16 v[164:167], v[130:133], v[20:23], v[164:167]
    v_mfma_f32_16x16x32_bf16 v[176:179], v[128:131], v[20:23], v[176:179]
    v_mfma_f32_16x16x32_bf16 v[168:171], v[130:133], v[24:27], v[168:171]
    v_mfma_f32_16x16x32_bf16 v[180:183], v[128:131], v[24:27], v[180:183]
    s_waitcnt vmcnt(3)
    s_barrier
    s_add_u32 m0, s8, 0
    s_add_u32 s5, s12, 0
    buffer_load_dwordx4 v5, s[60:63], s5 offen offset:0 lds
    buffer_load_dwordx4 v6, s[60:63], s5 offen offset:1024 lds
    s_add_u32 m0, s8, 0
    s_add_u32 s5, s12, 0
    buffer_load_dwordx4 v7, s[60:63], s5 offen offset:2048 lds
    buffer_load_dwordx4 v8, s[60:63], s5 offen offset:3072 lds
    s_add_u32 m0, s8, 16384
    s_add_u32 s5, s12, 57344
    buffer_load_dwordx4 v5, s[60:63], s5 offen offset:0 lds
    buffer_load_dwordx4 v6, s[60:63], s5 offen offset:1024 lds
    buffer_load_dwordx4 v7, s[60:63], s5 offen offset:2048 lds
    buffer_load_dwordx4 v8, s[60:63], s5 offen offset:3072 lds
    s_add_u32 m0, s8, 32768
    s_add_u32 s5, s12, 114688
    buffer_load_dwordx4 v5, s[60:63], s5 offen offset:0 lds
    buffer_load_dwordx4 v6, s[60:63], s5 offen offset:1024 lds
    buffer_load_dwordx4 v7, s[60:63], s5 offen offset:2048 lds
    buffer_load_dwordx4 v8, s[60:63], s5 offen offset:3072 lds
    s_add_u32 m0, s8, 49152
    s_add_u32 s5, s12, 172032
    buffer_load_dwordx4 v5, s[60:63], s5 offen offset:0 lds
    buffer_load_dwordx4 v6, s[60:63], s5 offen offset:1024 lds
    buffer_load_dwordx4 v7, s[60:63], s5 offen offset:2048 lds
    buffer_load_dwordx4 v8, s[60:63], s5 offen offset:3072 lds
    s_add_u32 s12, s12, 128
    s_sub_u32 s5, s12, 896
    s_cmp_eq_u32 s5, s16
    s_cselect_b32 s12, s5, s12
    s_waitcnt vmcnt(11)
    buffer_load_dwordx4 v[48:51], v12, s[64:67], s46 offen offset:0 sc1
    s_waitcnt vmcnt(11)
    buffer_load_dwordx4 v[52:55], v12, s[64:67], s46 offen offset:1024 sc1
    s_waitcnt vmcnt(11)
    buffer_load_dwordx4 v[56:59], v12, s[64:67], s46 offen offset:2048 sc1
L_yt1:
    v_bitop3_b32 v232, v32, v36, v144 bitop3:0x7e
    v_bitop3_b32 v233, v33, v37, v145 bitop3:0x7e
    v_bitop3_b32 v234, v34, v38, v146 bitop3:0x7e
    v_bitop3_b32 v235, v35, v39, v147 bitop3:0x7e
    v_bitop3_b32 v232, v232, v40, v144 bitop3:0xf6
    v_bitop3_b32 v233, v233, v41, v145 bitop3:0xf6
    v_bitop3_b32 v234, v234, v42, v146 bitop3:0xf6
    v_bitop3_b32 v235, v235, v43, v147 bitop3:0xf6
    v_or3_b32 v4, v232, v233, v234
    v_bitop3_b32 v4, v4, v235, s6 bitop3:0xa8
    v_cmp_ne_u32 vcc, 0, v4
    v_or_b32 v32, s6, v32
    v_or_b32 v33, s6, v33
    v_or_b32 v34, s6, v34
    v_or_b32 v35, s6, v35
    v_or_b32 v36, s6, v36
    v_or_b32 v37, s6, v37
    v_or_b32 v38, s6, v38
    v_or_b32 v39, s6, v39
    v_or_b32 v40, s6, v40
    v_or_b32 v41, s6, v41
    v_or_b32 v42, s6, v42
    v_or_b32 v43, s6, v43
    s_cbranch_vccnz L_yt1_r
    v_mfma_f32_16x16x32_bf16 v[160:163], v[130:133], v[32:35], v[160:163]
    v_mfma_f32_16x16x32_bf16 v[172:175], v[128:131], v[32:35], v[172:175]
    v_mfma_f32_16x16x32_bf16 v[164:167], v[130:133], v[36:39], v[164:167]
    v_mfma_f32_16x16x32_bf16 v[176:179], v[128:131], v[36:39], v[176:179]
    v_mfma_f32_16x16x32_bf16 v[168:171], v[130:133], v[40:43], v[168:171]
    v_mfma_f32_16x16x32_bf16 v[180:183], v[128:131], v[40:43], v[180:183]
    s_cmp_eq_u32 s39, 0
    s_cbranch_scc1 L_cc
    s_cmp_gt_u32 s39, 3
    s_cbranch_scc1 L_cb
    s_waitcnt vmcnt(3)
    s_barrier
    buffer_load_dwordx4 v[112:115], v12, s[64:67], s50 offen offset:0 sc1
    buffer_load_dwordx4 v[116:119], v12, s[64:67], s50 offen offset:1024 sc1
    buffer_load_dwordx4 v[120:123], v12, s[64:67], s50 offen offset:2048 sc1
    s_waitcnt vmcnt(3)
L_at2:
    v_bitop3_b32 v232, v48, v52, v144 bitop3:0x7e
    v_bitop3_b32 v233, v49, v53, v145 bitop3:0x7e
    v_bitop3_b32 v234, v50, v54, v146 bitop3:0x7e
    v_bitop3_b32 v235, v51, v55, v147 bitop3:0x7e
    v_bitop3_b32 v232, v232, v56, v144 bitop3:0xf6
    v_bitop3_b32 v233, v233, v57, v145 bitop3:0xf6
    v_bitop3_b32 v234, v234, v58, v146 bitop3:0xf6
    v_bitop3_b32 v235, v235, v59, v147 bitop3:0xf6
    v_or3_b32 v4, v232, v233, v234
    v_bitop3_b32 v4, v4, v235, s6 bitop3:0xa8
    v_cmp_ne_u32 vcc, 0, v4
    v_or_b32 v48, s6, v48
    v_or_b32 v49, s6, v49
    v_or_b32 v50, s6, v50
    v_or_b32 v51, s6, v51
    v_or_b32 v52, s6, v52
    v_or_b32 v53, s6, v53
    v_or_b32 v54, s6, v54
    v_or_b32 v55, s6, v55
    v_or_b32 v56, s6, v56
    v_or_b32 v57, s6, v57
    v_or_b32 v58, s6, v58
    v_or_b32 v59, s6, v59
    s_cbranch_vccnz L_at2_r
    v_mfma_f32_16x16x32_bf16 v[160:163], v[130:133], v[48:51], v[160:163]
    v_mfma_f32_16x16x32_bf16 v[172:175], v[128:131], v[48:51], v[172:175]
    v_mfma_f32_16x16x32_bf16 v[164:167], v[130:133], v[52:55], v[164:167]
    v_mfma_f32_16x16x32_bf16 v[176:179], v[128:131], v[52:55], v[176:179]
    v_mfma_f32_16x16x32_bf16 v[168:171], v[130:133], v[56:59], v[168:171]
    v_mfma_f32_16x16x32_bf16 v[180:183], v[128:131], v[56:59], v[180:183]
    buffer_store_dwordx2 v[152:153], v9, s[64:67], s13 offen sc1
    s_waitcnt vmcnt(1)
L_at6:
    v_bitop3_b32 v232, v112, v116, v144 bitop3:0x7e
    v_bitop3_b32 v233, v113, v117, v145 bitop3:0x7e
    v_bitop3_b32 v234, v114, v118, v146 bitop3:0x7e
    v_bitop3_b32 v235, v115, v119, v147 bitop3:0x7e
    v_bitop3_b32 v232, v232, v120, v144 bitop3:0xf6
    v_bitop3_b32 v233, v233, v121, v145 bitop3:0xf6
    v_bitop3_b32 v234, v234, v122, v146 bitop3:0xf6
    v_bitop3_b32 v235, v235, v123, v147 bitop3:0xf6
    v_or3_b32 v4, v232, v233, v234
    v_bitop3_b32 v4, v4, v235, s6 bitop3:0xa8
    v_cmp_ne_u32 vcc, 0, v4
    v_or_b32 v112, s6, v112
    v_or_b32 v113, s6, v113
    v_or_b32 v114, s6, v114
    v_or_b32 v115, s6, v115
    v_or_b32 v116, s6, v116
    v_or_b32 v117, s6, v117
    v_or_b32 v118, s6, v118
    v_or_b32 v119, s6, v119
    v_or_b32 v120, s6, v120
    v_or_b32 v121, s6, v121
    v_or_b32 v122, s6, v122
    v_or_b32 v123, s6, v123
    s_cbranch_vccnz L_at6_r
    v_mfma_f32_16x16x32_bf16 v[160:163], v[130:133], v[112:115], v[160:163]
    v_mfma_f32_16x16x32_bf16 v[172:175], v[128:131], v[112:115], v[172:175]
    v_mfma_f32_16x16x32_bf16 v[164:167], v[130:133], v[116:119], v[164:167]
    v_mfma_f32_16x16x32_bf16 v[176:179], v[128:131], v[116:119], v[176:179]
    v_mfma_f32_16x16x32_bf16 v[168:171], v[130:133], v[120:123], v[168:171]
    v_mfma_f32_16x16x32_bf16 v[180:183], v[128:131], v[120:123], v[180:183]
    s_waitcnt vmcnt(0)
    buffer_load_dwordx2 v[140:141], v2, s[64:67], s9 offen sc1
    s_waitcnt vmcnt(0)
L_ak:
    v_cmp_ne_u64 vcc, v[140:141], v[152:153]
    s_and_b32 s5, vcc_lo, s51
    s_cbranch_scc1 L_ak_r
    buffer_load_dwordx4 v[64:67], v12, s[64:67], s47 offen offset:0 sc1
    buffer_load_dwordx4 v[68:71], v12, s[64:67], s47 offen offset:1024 sc1
    buffer_load_dwordx4 v[72:75], v12, s[64:67], s47 offen offset:2048 sc1
    buffer_load_dwordx4 v[80:83], v12, s[64:67], s48 offen offset:0 sc1
    buffer_load_dwordx4 v[84:87], v12, s[64:67], s48 offen offset:1024 sc1
    buffer_load_dwordx4 v[88:91], v12, s[64:67], s48 offen offset:2048 sc1
    s_barrier
    ds_read2st64_b32 v[184:185], v10 offset0:0 offset1:1
    ds_read2st64_b32 v[186:187], v10 offset0:6 offset1:7
    ds_read2st64_b32 v[188:189], v10 offset0:2 offset1:3
    ds_read2st64_b32 v[190:191], v10 offset0:8 offset1:9
    ds_read2st64_b32 v[192:193], v10 offset0:4 offset1:5
    ds_read2st64_b32 v[194:195], v10 offset0:10 offset1:11
    ds_read_b128 v[208:211], v11 offset:0
    ds_read_b128 v[220:223], v11 offset:3072
    ds_read_b128 v[212:215], v11 offset:1024
    ds_read_b128 v[224:227], v11 offset:4096
    ds_read_b128 v[216:219], v11 offset:2048
    ds_read_b128 v[228:231], v11 offset:5120
    s_waitcnt lgkmcnt(5)
    v_mfma_f32_16x16x32_bf16 v[208:211], v[130:133], v[184:187], v[208:211]
    s_waitcnt lgkmcnt(4)
    v_mfma_f32_16x16x32_bf16 v[220:223], v[128:131], v[184:187], v[220:223]
    s_waitcnt lgkmcnt(3)
    v_mfma_f32_16x16x32_bf16 v[212:215], v[130:133], v[188:191], v[212:215]
    s_waitcnt lgkmcnt(2)
    v_mfma_f32_16x16x32_bf16 v[224:227], v[128:131], v[188:191], v[224:227]
    s_waitcnt lgkmcnt(1)
    v_mfma_f32_16x16x32_bf16 v[216:219], v[130:133], v[192:195], v[216:219]
    s_waitcnt lgkmcnt(0)
    v_mfma_f32_16x16x32_bf16 v[228:231], v[128:131], v[192:195], v[228:231]
    buffer_load_dwordx4 v[96:99], v12, s[64:67], s49 offen offset:0 sc1
    buffer_load_dwordx4 v[100:103], v12, s[64:67], s49 offen offset:1024 sc1
    buffer_load_dwordx4 v[104:107], v12, s[64:67], s49 offen offset:2048 sc1
    v_pk_add_f32 v[160:161], v[160:161], v[208:209]
    v_pk_add_f32 v[162:163], v[162:163], v[210:211]
    v_pk_add_f32 v[172:173], v[172:173], v[220:221]
    v_pk_add_f32 v[174:175], v[174:175], v[222:223]
    v_pk_add_f32 v[164:165], v[164:165], v[212:213]
    v_pk_add_f32 v[166:167], v[166:167], v[214:215]
    v_pk_add_f32 v[176:177], v[176:177], v[224:225]
    v_pk_add_f32 v[178:179], v[178:179], v[226:227]
    v_pk_add_f32 v[168:169], v[168:169], v[216:217]
    v_pk_add_f32 v[170:171], v[170:171], v[218:219]
    v_pk_add_f32 v[180:181], v[180:181], v[228:229]
    v_pk_add_f32 v[182:183], v[182:183], v[230:231]
    s_waitcnt vmcnt(6)
    v_bitop3_b32 v232, v64, v68, v144 bitop3:0x7e
    v_bitop3_b32 v233, v65, v69, v145 bitop3:0x7e
    v_bitop3_b32 v234, v66, v70, v146 bitop3:0x7e
    v_bitop3_b32 v235, v67, v71, v147 bitop3:0x7e
    v_bitop3_b32 v232, v232, v72, v144 bitop3:0xf6
    v_bitop3_b32 v233, v233, v73, v145 bitop3:0xf6
    v_bitop3_b32 v234, v234, v74, v146 bitop3:0xf6
    v_bitop3_b32 v235, v235, v75, v147 bitop3:0xf6
    v_or3_b32 v4, v232, v233, v234
    v_bitop3_b32 v4, v4, v235, s6 bitop3:0xa8
    v_cmp_ne_u32 vcc, 0, v4
    v_or_b32 v64, s6, v64
    v_or_b32 v65, s6, v65
    v_or_b32 v66, s6, v66
    v_or_b32 v67, s6, v67
    v_or_b32 v68, s6, v68
    v_or_b32 v69, s6, v69
    v_or_b32 v70, s6, v70
    v_or_b32 v71, s6, v71
    v_or_b32 v72, s6, v72
    v_or_b32 v73, s6, v73
    v_or_b32 v74, s6, v74
    v_or_b32 v75, s6, v75
    s_cbranch_vccnz L_aj3_r
L_aj3:
    v_mfma_f32_16x16x32_bf16 v[160:163], v[130:133], v[64:67], v[160:163]
    s_waitcnt vmcnt(3)
    v_bitop3_b32 v232, v80, v84, v144 bitop3:0x7e
    v_bitop3_b32 v233, v81, v85, v145 bitop3:0x7e
    v_mfma_f32_16x16x32_bf16 v[172:175], v[128:131], v[64:67], v[172:175]
    v_bitop3_b32 v234, v82, v86, v146 bitop3:0x7e
    v_bitop3_b32 v235, v83, v87, v147 bitop3:0x7e
    v_mfma_f32_16x16x32_bf16 v[164:167], v[130:133], v[68:71], v[164:167]
    v_bitop3_b32 v232, v232, v88, v144 bitop3:0xf6
    v_bitop3_b32 v233, v233, v89, v145 bitop3:0xf6
    v_mfma_f32_16x16x32_bf16 v[176:179], v[128:131], v[68:71], v[176:179]
    v_bitop3_b32 v234, v234, v90, v146 bitop3:0xf6
    v_bitop3_b32 v235, v235, v91, v147 bitop3:0xf6
    v_mfma_f32_16x16x32_bf16 v[168:171], v[130:133], v[72:75], v[168:171]
    v_or3_b32 v4, v232, v233, v234
    v_bitop3_b32 v4, v4, v235, s6 bitop3:0xa8
    v_mfma_f32_16x16x32_bf16 v[180:183], v[128:131], v[72:75], v[180:183]
    v_cmp_ne_u32 vcc, 0, v4
    v_or_b32 v80, s6, v80
    v_or_b32 v81, s6, v81
    v_or_b32 v82, s6, v82
    v_or_b32 v83, s6, v83
    v_or_b32 v84, s6, v84
    v_or_b32 v85, s6, v85
    v_or_b32 v86, s6, v86
    v_or_b32 v87, s6, v87
    v_or_b32 v88, s6, v88
    v_or_b32 v89, s6, v89
    v_or_b32 v90, s6, v90
    v_or_b32 v91, s6, v91
    s_cbranch_vccnz L_aj4_r
L_aj4:
    v_mfma_f32_16x16x32_bf16 v[160:163], v[130:133], v[80:83], v[160:163]
    s_waitcnt vmcnt(0)
    v_bitop3_b32 v232, v96, v100, v144 bitop3:0x7e
    v_bitop3_b32 v233, v97, v101, v145 bitop3:0x7e
    v_mfma_f32_16x16x32_bf16 v[172:175], v[128:131], v[80:83], v[172:175]
    v_bitop3_b32 v234, v98, v102, v146 bitop3:0x7e
    v_bitop3_b32 v235, v99, v103, v147 bitop3:0x7e
    v_mfma_f32_16x16x32_bf16 v[164:167], v[130:133], v[84:87], v[164:167]
    v_bitop3_b32 v232, v232, v104, v144 bitop3:0xf6
    v_bitop3_b32 v233, v233, v105, v145 bitop3:0xf6
    v_mfma_f32_16x16x32_bf16 v[176:179], v[128:131], v[84:87], v[176:179]
    v_bitop3_b32 v234, v234, v106, v146 bitop3:0xf6
    v_bitop3_b32 v235, v235, v107, v147 bitop3:0xf6
    v_mfma_f32_16x16x32_bf16 v[168:171], v[130:133], v[88:91], v[168:171]
    v_or3_b32 v4, v232, v233, v234
    v_bitop3_b32 v4, v4, v235, s6 bitop3:0xa8
    v_mfma_f32_16x16x32_bf16 v[180:183], v[128:131], v[88:91], v[180:183]
    v_cmp_ne_u32 vcc, 0, v4
    v_or_b32 v96, s6, v96
    v_or_b32 v97, s6, v97
    v_or_b32 v98, s6, v98
    v_or_b32 v99, s6, v99
    v_or_b32 v100, s6, v100
    v_or_b32 v101, s6, v101
    v_or_b32 v102, s6, v102
    v_or_b32 v103, s6, v103
    v_or_b32 v104, s6, v104
    v_or_b32 v105, s6, v105
    v_or_b32 v106, s6, v106
    v_or_b32 v107, s6, v107
    s_cbranch_vccnz L_aj5_r
L_aj5:
    v_mfma_f32_16x16x32_bf16 v[160:163], v[130:133], v[96:99], v[160:163]
    v_mfma_f32_16x16x32_bf16 v[172:175], v[128:131], v[96:99], v[172:175]
    v_mfma_f32_16x16x32_bf16 v[164:167], v[130:133], v[100:103], v[164:167]
    v_mfma_f32_16x16x32_bf16 v[176:179], v[128:131], v[100:103], v[176:179]
    v_mfma_f32_16x16x32_bf16 v[168:171], v[130:133], v[104:107], v[168:171]
    v_mfma_f32_16x16x32_bf16 v[180:183], v[128:131], v[104:107], v[180:183]
    s_nop 2
    v_cvt_pk_bf16_f32 v184, v160, v161
    v_cvt_pk_bf16_f32 v186, v172, v173
    v_cvt_pk_bf16_f32 v185, v162, v163
    v_cvt_pk_bf16_f32 v187, v174, v175
    v_cvt_pk_bf16_f32 v188, v164, v165
    v_cvt_pk_bf16_f32 v190, v176, v177
    v_cvt_pk_bf16_f32 v189, v166, v167
    v_cvt_pk_bf16_f32 v191, v178, v179
    v_cvt_pk_bf16_f32 v192, v168, v169
    v_cvt_pk_bf16_f32 v194, v180, v181
    v_cvt_pk_bf16_f32 v193, v170, v171
    v_cvt_pk_bf16_f32 v195, v182, v183
    v_permlane16_swap_b32 v184, v186
    v_permlane16_swap_b32 v185, v187
    buffer_store_dwordx4 v[184:187], v3, s[32:35], s10 offen
    v_permlane16_swap_b32 v188, v190
    v_permlane16_swap_b32 v189, v191
    s_add_u32 s10, s10, 28672
    buffer_store_dwordx4 v[188:191], v3, s[32:35], s10 offen
    v_permlane16_swap_b32 v192, v194
    v_permlane16_swap_b32 v193, v195
    s_add_u32 s10, s10, 28672
    buffer_store_dwordx4 v[192:195], v3, s[32:35], s10 offen
    s_endpgm
L_cb:
    s_waitcnt vmcnt(3)
    s_barrier
    s_waitcnt vmcnt(0)
L_bt2:
    v_bitop3_b32 v232, v48, v52, v144 bitop3:0x7e
    v_bitop3_b32 v233, v49, v53, v145 bitop3:0x7e
    v_bitop3_b32 v234, v50, v54, v146 bitop3:0x7e
    v_bitop3_b32 v235, v51, v55, v147 bitop3:0x7e
    v_bitop3_b32 v232, v232, v56, v144 bitop3:0xf6
    v_bitop3_b32 v233, v233, v57, v145 bitop3:0xf6
    v_bitop3_b32 v234, v234, v58, v146 bitop3:0xf6
    v_bitop3_b32 v235, v235, v59, v147 bitop3:0xf6
    v_or3_b32 v4, v232, v233, v234
    v_bitop3_b32 v4, v4, v235, s6 bitop3:0xa8
    v_cmp_ne_u32 vcc, 0, v4
    v_or_b32 v48, s6, v48
    v_or_b32 v49, s6, v49
    v_or_b32 v50, s6, v50
    v_or_b32 v51, s6, v51
    v_or_b32 v52, s6, v52
    v_or_b32 v53, s6, v53
    v_or_b32 v54, s6, v54
    v_or_b32 v55, s6, v55
    v_or_b32 v56, s6, v56
    v_or_b32 v57, s6, v57
    v_or_b32 v58, s6, v58
    v_or_b32 v59, s6, v59
    s_cbranch_vccnz L_bt2_r
    v_mfma_f32_16x16x32_bf16 v[160:163], v[130:133], v[48:51], v[160:163]
    v_mfma_f32_16x16x32_bf16 v[172:175], v[128:131], v[48:51], v[172:175]
    v_mfma_f32_16x16x32_bf16 v[164:167], v[130:133], v[52:55], v[164:167]
    v_mfma_f32_16x16x32_bf16 v[176:179], v[128:131], v[52:55], v[176:179]
    v_mfma_f32_16x16x32_bf16 v[168:171], v[130:133], v[56:59], v[168:171]
    v_mfma_f32_16x16x32_bf16 v[180:183], v[128:131], v[56:59], v[180:183]
    buffer_store_dwordx2 v[152:153], v9, s[64:67], s13 offen sc1
    s_waitcnt vmcnt(0)
    buffer_load_dwordx2 v[140:141], v2, s[64:67], s9 offen sc1
    s_bitset1_b32 s51, 7
    s_waitcnt vmcnt(0)
L_bk:
    v_cmp_ne_u64 vcc, v[140:141], v[152:153]
    s_and_b32 s5, vcc_lo, s51
    s_cbranch_scc1 L_bk_r
    buffer_load_dwordx4 v[64:67], v12, s[64:67], s47 offen offset:0 sc1
    buffer_load_dwordx4 v[68:71], v12, s[64:67], s47 offen offset:1024 sc1
    buffer_load_dwordx4 v[72:75], v12, s[64:67], s47 offen offset:2048 sc1
    buffer_load_dwordx4 v[80:83], v12, s[64:67], s48 offen offset:0 sc1
    buffer_load_dwordx4 v[84:87], v12, s[64:67], s48 offen offset:1024 sc1
    buffer_load_dwordx4 v[88:91], v12, s[64:67], s48 offen offset:2048 sc1
    s_barrier
    ds_read2st64_b32 v[184:185], v10 offset0:0 offset1:1
    ds_read2st64_b32 v[186:187], v10 offset0:6 offset1:7
    ds_read2st64_b32 v[188:189], v10 offset0:2 offset1:3
    ds_read2st64_b32 v[190:191], v10 offset0:8 offset1:9
    ds_read2st64_b32 v[192:193], v10 offset0:4 offset1:5
    ds_read2st64_b32 v[194:195], v10 offset0:10 offset1:11
    ds_read_b128 v[208:211], v11 offset:0
    ds_read_b128 v[220:223], v11 offset:3072
    ds_read_b128 v[212:215], v11 offset:1024
    ds_read_b128 v[224:227], v11 offset:4096
    ds_read_b128 v[216:219], v11 offset:2048
    ds_read_b128 v[228:231], v11 offset:5120
    s_waitcnt lgkmcnt(5)
    v_mfma_f32_16x16x32_bf16 v[208:211], v[130:133], v[184:187], v[208:211]
    s_waitcnt lgkmcnt(4)
    v_mfma_f32_16x16x32_bf16 v[220:223], v[128:131], v[184:187], v[220:223]
    s_waitcnt lgkmcnt(3)
    v_mfma_f32_16x16x32_bf16 v[212:215], v[130:133], v[188:191], v[212:215]
    s_waitcnt lgkmcnt(2)
    v_mfma_f32_16x16x32_bf16 v[224:227], v[128:131], v[188:191], v[224:227]
    s_waitcnt lgkmcnt(1)
    v_mfma_f32_16x16x32_bf16 v[216:219], v[130:133], v[192:195], v[216:219]
    s_waitcnt lgkmcnt(0)
    v_mfma_f32_16x16x32_bf16 v[228:231], v[128:131], v[192:195], v[228:231]
    buffer_load_dwordx4 v[96:99], v12, s[64:67], s49 offen offset:0 sc1
    buffer_load_dwordx4 v[100:103], v12, s[64:67], s49 offen offset:1024 sc1
    buffer_load_dwordx4 v[104:107], v12, s[64:67], s49 offen offset:2048 sc1
    buffer_load_dwordx4 v[112:115], v12, s[64:67], s50 offen offset:0 sc1
    buffer_load_dwordx4 v[116:119], v12, s[64:67], s50 offen offset:1024 sc1
    buffer_load_dwordx4 v[120:123], v12, s[64:67], s50 offen offset:2048 sc1
    v_pk_add_f32 v[160:161], v[160:161], v[208:209]
    v_pk_add_f32 v[162:163], v[162:163], v[210:211]
    v_pk_add_f32 v[172:173], v[172:173], v[220:221]
    v_pk_add_f32 v[174:175], v[174:175], v[222:223]
    v_pk_add_f32 v[164:165], v[164:165], v[212:213]
    v_pk_add_f32 v[166:167], v[166:167], v[214:215]
    v_pk_add_f32 v[176:177], v[176:177], v[224:225]
    v_pk_add_f32 v[178:179], v[178:179], v[226:227]
    v_pk_add_f32 v[168:169], v[168:169], v[216:217]
    v_pk_add_f32 v[170:171], v[170:171], v[218:219]
    v_pk_add_f32 v[180:181], v[180:181], v[228:229]
    v_pk_add_f32 v[182:183], v[182:183], v[230:231]
    s_waitcnt vmcnt(9)
    v_bitop3_b32 v232, v64, v68, v144 bitop3:0x7e
    v_bitop3_b32 v233, v65, v69, v145 bitop3:0x7e
    v_bitop3_b32 v234, v66, v70, v146 bitop3:0x7e
    v_bitop3_b32 v235, v67, v71, v147 bitop3:0x7e
    v_bitop3_b32 v232, v232, v72, v144 bitop3:0xf6
    v_bitop3_b32 v233, v233, v73, v145 bitop3:0xf6
    v_bitop3_b32 v234, v234, v74, v146 bitop3:0xf6
    v_bitop3_b32 v235, v235, v75, v147 bitop3:0xf6
    v_or3_b32 v4, v232, v233, v234
    v_bitop3_b32 v4, v4, v235, s6 bitop3:0xa8
    v_cmp_ne_u32 vcc, 0, v4
    v_or_b32 v64, s6, v64
    v_or_b32 v65, s6, v65
    v_or_b32 v66, s6, v66
    v_or_b32 v67, s6, v67
    v_or_b32 v68, s6, v68
    v_or_b32 v69, s6, v69
    v_or_b32 v70, s6, v70
    v_or_b32 v71, s6, v71
    v_or_b32 v72, s6, v72
    v_or_b32 v73, s6, v73
    v_or_b32 v74, s6, v74
    v_or_b32 v75, s6, v75
    s_cbranch_vccnz L_bj3_r
L_bj3:
    v_mfma_f32_16x16x32_bf16 v[160:163], v[130:133], v[64:67], v[160:163]
    s_waitcnt vmcnt(6)
    v_bitop3_b32 v232, v80, v84, v144 bitop3:0x7e
    v_bitop3_b32 v233, v81, v85, v145 bitop3:0x7e
    v_mfma_f32_16x16x32_bf16 v[172:175], v[128:131], v[64:67], v[172:175]
    v_bitop3_b32 v234, v82, v86, v146 bitop3:0x7e
    v_bitop3_b32 v235, v83, v87, v147 bitop3:0x7e
    v_mfma_f32_16x16x32_bf16 v[164:167], v[130:133], v[68:71], v[164:167]
    v_bitop3_b32 v232, v232, v88, v144 bitop3:0xf6
    v_bitop3_b32 v233, v233, v89, v145 bitop3:0xf6
    v_mfma_f32_16x16x32_bf16 v[176:179], v[128:131], v[68:71], v[176:179]
    v_bitop3_b32 v234, v234, v90, v146 bitop3:0xf6
    v_bitop3_b32 v235, v235, v91, v147 bitop3:0xf6
    v_mfma_f32_16x16x32_bf16 v[168:171], v[130:133], v[72:75], v[168:171]
    v_or3_b32 v4, v232, v233, v234
    v_bitop3_b32 v4, v4, v235, s6 bitop3:0xa8
    v_mfma_f32_16x16x32_bf16 v[180:183], v[128:131], v[72:75], v[180:183]
    v_cmp_ne_u32 vcc, 0, v4
    v_or_b32 v80, s6, v80
    v_or_b32 v81, s6, v81
    v_or_b32 v82, s6, v82
    v_or_b32 v83, s6, v83
    v_or_b32 v84, s6, v84
    v_or_b32 v85, s6, v85
    v_or_b32 v86, s6, v86
    v_or_b32 v87, s6, v87
    v_or_b32 v88, s6, v88
    v_or_b32 v89, s6, v89
    v_or_b32 v90, s6, v90
    v_or_b32 v91, s6, v91
    s_cbranch_vccnz L_bj4_r
L_bj4:
    v_mfma_f32_16x16x32_bf16 v[160:163], v[130:133], v[80:83], v[160:163]
    s_waitcnt vmcnt(3)
    v_bitop3_b32 v232, v96, v100, v144 bitop3:0x7e
    v_bitop3_b32 v233, v97, v101, v145 bitop3:0x7e
    v_mfma_f32_16x16x32_bf16 v[172:175], v[128:131], v[80:83], v[172:175]
    v_bitop3_b32 v234, v98, v102, v146 bitop3:0x7e
    v_bitop3_b32 v235, v99, v103, v147 bitop3:0x7e
    v_mfma_f32_16x16x32_bf16 v[164:167], v[130:133], v[84:87], v[164:167]
    v_bitop3_b32 v232, v232, v104, v144 bitop3:0xf6
    v_bitop3_b32 v233, v233, v105, v145 bitop3:0xf6
    v_mfma_f32_16x16x32_bf16 v[176:179], v[128:131], v[84:87], v[176:179]
    v_bitop3_b32 v234, v234, v106, v146 bitop3:0xf6
    v_bitop3_b32 v235, v235, v107, v147 bitop3:0xf6
    v_mfma_f32_16x16x32_bf16 v[168:171], v[130:133], v[88:91], v[168:171]
    v_or3_b32 v4, v232, v233, v234
    v_bitop3_b32 v4, v4, v235, s6 bitop3:0xa8
    v_mfma_f32_16x16x32_bf16 v[180:183], v[128:131], v[88:91], v[180:183]
    v_cmp_ne_u32 vcc, 0, v4
    v_or_b32 v96, s6, v96
    v_or_b32 v97, s6, v97
    v_or_b32 v98, s6, v98
    v_or_b32 v99, s6, v99
    v_or_b32 v100, s6, v100
    v_or_b32 v101, s6, v101
    v_or_b32 v102, s6, v102
    v_or_b32 v103, s6, v103
    v_or_b32 v104, s6, v104
    v_or_b32 v105, s6, v105
    v_or_b32 v106, s6, v106
    v_or_b32 v107, s6, v107
    s_cbranch_vccnz L_bj5_r
L_bj5:
    v_mfma_f32_16x16x32_bf16 v[160:163], v[130:133], v[96:99], v[160:163]
    s_waitcnt vmcnt(0)
    v_bitop3_b32 v232, v112, v116, v144 bitop3:0x7e
    v_bitop3_b32 v233, v113, v117, v145 bitop3:0x7e
    v_mfma_f32_16x16x32_bf16 v[172:175], v[128:131], v[96:99], v[172:175]
    v_bitop3_b32 v234, v114, v118, v146 bitop3:0x7e
    v_bitop3_b32 v235, v115, v119, v147 bitop3:0x7e
    v_mfma_f32_16x16x32_bf16 v[164:167], v[130:133], v[100:103], v[164:167]
    v_bitop3_b32 v232, v232, v120, v144 bitop3:0xf6
    v_bitop3_b32 v233, v233, v121, v145 bitop3:0xf6
    v_mfma_f32_16x16x32_bf16 v[176:179], v[128:131], v[100:103], v[176:179]
    v_bitop3_b32 v234, v234, v122, v146 bitop3:0xf6
    v_bitop3_b32 v235, v235, v123, v147 bitop3:0xf6
    v_mfma_f32_16x16x32_bf16 v[168:171], v[130:133], v[104:107], v[168:171]
    v_or3_b32 v4, v232, v233, v234
    v_bitop3_b32 v4, v4, v235, s6 bitop3:0xa8
    v_mfma_f32_16x16x32_bf16 v[180:183], v[128:131], v[104:107], v[180:183]
    v_cmp_ne_u32 vcc, 0, v4
    v_or_b32 v112, s6, v112
    v_or_b32 v113, s6, v113
    v_or_b32 v114, s6, v114
    v_or_b32 v115, s6, v115
    v_or_b32 v116, s6, v116
    v_or_b32 v117, s6, v117
    v_or_b32 v118, s6, v118
    v_or_b32 v119, s6, v119
    v_or_b32 v120, s6, v120
    v_or_b32 v121, s6, v121
    v_or_b32 v122, s6, v122
    v_or_b32 v123, s6, v123
    s_cbranch_vccnz L_bj6_r
L_bj6:
    v_mfma_f32_16x16x32_bf16 v[160:163], v[130:133], v[112:115], v[160:163]
    v_mfma_f32_16x16x32_bf16 v[172:175], v[128:131], v[112:115], v[172:175]
    v_mfma_f32_16x16x32_bf16 v[164:167], v[130:133], v[116:119], v[164:167]
    v_mfma_f32_16x16x32_bf16 v[176:179], v[128:131], v[116:119], v[176:179]
    v_mfma_f32_16x16x32_bf16 v[168:171], v[130:133], v[120:123], v[168:171]
    v_mfma_f32_16x16x32_bf16 v[180:183], v[128:131], v[120:123], v[180:183]
    s_nop 2
    v_cvt_pk_bf16_f32 v184, v160, v161
    v_cvt_pk_bf16_f32 v186, v172, v173
    v_cvt_pk_bf16_f32 v185, v162, v163
    v_cvt_pk_bf16_f32 v187, v174, v175
    v_cvt_pk_bf16_f32 v188, v164, v165
    v_cvt_pk_bf16_f32 v190, v176, v177
    v_cvt_pk_bf16_f32 v189, v166, v167
    v_cvt_pk_bf16_f32 v191, v178, v179
    v_cvt_pk_bf16_f32 v192, v168, v169
    v_cvt_pk_bf16_f32 v194, v180, v181
    v_cvt_pk_bf16_f32 v193, v170, v171
    v_cvt_pk_bf16_f32 v195, v182, v183
    v_permlane16_swap_b32 v184, v186
    v_permlane16_swap_b32 v185, v187
    buffer_store_dwordx4 v[184:187], v3, s[32:35], s10 offen
    v_permlane16_swap_b32 v188, v190
    v_permlane16_swap_b32 v189, v191
    s_add_u32 s10, s10, 28672
    buffer_store_dwordx4 v[188:191], v3, s[32:35], s10 offen
    v_permlane16_swap_b32 v192, v194
    v_permlane16_swap_b32 v193, v195
    s_add_u32 s10, s10, 28672
    buffer_store_dwordx4 v[192:195], v3, s[32:35], s10 offen
    s_endpgm
L_cc:
    s_waitcnt vmcnt(3)
    s_barrier
    s_waitcnt vmcnt(0)
L_ct2:
    v_bitop3_b32 v232, v48, v52, v144 bitop3:0x7e
    v_bitop3_b32 v233, v49, v53, v145 bitop3:0x7e
    v_bitop3_b32 v234, v50, v54, v146 bitop3:0x7e
    v_bitop3_b32 v235, v51, v55, v147 bitop3:0x7e
    v_bitop3_b32 v232, v232, v56, v144 bitop3:0xf6
    v_bitop3_b32 v233, v233, v57, v145 bitop3:0xf6
    v_bitop3_b32 v234, v234, v58, v146 bitop3:0xf6
    v_bitop3_b32 v235, v235, v59, v147 bitop3:0xf6
    v_or3_b32 v4, v232, v233, v234
    v_bitop3_b32 v4, v4, v235, s6 bitop3:0xa8
    v_cmp_ne_u32 vcc, 0, v4
    v_or_b32 v48, s6, v48
    v_or_b32 v49, s6, v49
    v_or_b32 v50, s6, v50
    v_or_b32 v51, s6, v51
    v_or_b32 v52, s6, v52
    v_or_b32 v53, s6, v53
    v_or_b32 v54, s6, v54
    v_or_b32 v55, s6, v55
    v_or_b32 v56, s6, v56
    v_or_b32 v57, s6, v57
    v_or_b32 v58, s6, v58
    v_or_b32 v59, s6, v59
    s_cbranch_vccnz L_ct2_r
    v_mfma_f32_16x16x32_bf16 v[160:163], v[130:133], v[48:51], v[160:163]
    v_mfma_f32_16x16x32_bf16 v[172:175], v[128:131], v[48:51], v[172:175]
    v_mfma_f32_16x16x32_bf16 v[164:167], v[130:133], v[52:55], v[164:167]
    v_mfma_f32_16x16x32_bf16 v[176:179], v[128:131], v[52:55], v[176:179]
    v_mfma_f32_16x16x32_bf16 v[168:171], v[130:133], v[56:59], v[168:171]
    v_mfma_f32_16x16x32_bf16 v[180:183], v[128:131], v[56:59], v[180:183]
    buffer_store_dwordx2 v[152:153], v9, s[64:67], s13 offen sc1
    s_waitcnt vmcnt(0)
    buffer_load_dwordx2 v[140:141], v2, s[64:67], s9 offen sc1
    s_waitcnt vmcnt(0)
L_ck:
    v_cmp_ne_u64 vcc, v[140:141], v[152:153]
    s_and_b32 s5, vcc_lo, s51
    s_cbranch_scc1 L_ck_r
    buffer_load_dwordx4 v[64:67], v12, s[64:67], s47 offen offset:0 sc1
    buffer_load_dwordx4 v[68:71], v12, s[64:67], s47 offen offset:1024 sc1
    buffer_load_dwordx4 v[72:75], v12, s[64:67], s47 offen offset:2048 sc1
    buffer_load_dwordx4 v[80:83], v12, s[64:67], s48 offen offset:0 sc1
    buffer_load_dwordx4 v[84:87], v12, s[64:67], s48 offen offset:1024 sc1
    buffer_load_dwordx4 v[88:91], v12, s[64:67], s48 offen offset:2048 sc1
    s_barrier
    ds_read2st64_b32 v[184:185], v10 offset0:0 offset1:1
    ds_read2st64_b32 v[186:187], v10 offset0:6 offset1:7
    ds_read2st64_b32 v[188:189], v10 offset0:2 offset1:3
    ds_read2st64_b32 v[190:191], v10 offset0:8 offset1:9
    ds_read2st64_b32 v[192:193], v10 offset0:4 offset1:5
    ds_read2st64_b32 v[194:195], v10 offset0:10 offset1:11
    ds_read_b128 v[208:211], v11 offset:0
    ds_read_b128 v[220:223], v11 offset:3072
    ds_read_b128 v[212:215], v11 offset:1024
    ds_read_b128 v[224:227], v11 offset:4096
    ds_read_b128 v[216:219], v11 offset:2048
    ds_read_b128 v[228:231], v11 offset:5120
    s_waitcnt lgkmcnt(5)
    v_mfma_f32_16x16x32_bf16 v[208:211], v[130:133], v[184:187], v[208:211]
    s_waitcnt lgkmcnt(4)
    v_mfma_f32_16x16x32_bf16 v[220:223], v[128:131], v[184:187], v[220:223]
    s_waitcnt lgkmcnt(3)
    v_mfma_f32_16x16x32_bf16 v[212:215], v[130:133], v[188:191], v[212:215]
    s_waitcnt lgkmcnt(2)
    v_mfma_f32_16x16x32_bf16 v[224:227], v[128:131], v[188:191], v[224:227]
    s_waitcnt lgkmcnt(1)
    v_mfma_f32_16x16x32_bf16 v[216:219], v[130:133], v[192:195], v[216:219]
    s_waitcnt lgkmcnt(0)
    v_mfma_f32_16x16x32_bf16 v[228:231], v[128:131], v[192:195], v[228:231]
    buffer_load_dwordx4 v[96:99], v12, s[64:67], s49 offen offset:0 sc1
    buffer_load_dwordx4 v[100:103], v12, s[64:67], s49 offen offset:1024 sc1
    buffer_load_dwordx4 v[104:107], v12, s[64:67], s49 offen offset:2048 sc1
    v_pk_add_f32 v[160:161], v[160:161], v[208:209]
    v_pk_add_f32 v[162:163], v[162:163], v[210:211]
    v_pk_add_f32 v[172:173], v[172:173], v[220:221]
    v_pk_add_f32 v[174:175], v[174:175], v[222:223]
    v_pk_add_f32 v[164:165], v[164:165], v[212:213]
    v_pk_add_f32 v[166:167], v[166:167], v[214:215]
    v_pk_add_f32 v[176:177], v[176:177], v[224:225]
    v_pk_add_f32 v[178:179], v[178:179], v[226:227]
    v_pk_add_f32 v[168:169], v[168:169], v[216:217]
    v_pk_add_f32 v[170:171], v[170:171], v[218:219]
    v_pk_add_f32 v[180:181], v[180:181], v[228:229]
    v_pk_add_f32 v[182:183], v[182:183], v[230:231]
    s_waitcnt vmcnt(6)
    v_bitop3_b32 v232, v64, v68, v144 bitop3:0x7e
    v_bitop3_b32 v233, v65, v69, v145 bitop3:0x7e
    v_bitop3_b32 v234, v66, v70, v146 bitop3:0x7e
    v_bitop3_b32 v235, v67, v71, v147 bitop3:0x7e
    v_bitop3_b32 v232, v232, v72, v144 bitop3:0xf6
    v_bitop3_b32 v233, v233, v73, v145 bitop3:0xf6
    v_bitop3_b32 v234, v234, v74, v146 bitop3:0xf6
    v_bitop3_b32 v235, v235, v75, v147 bitop3:0xf6
    v_or3_b32 v4, v232, v233, v234
    v_bitop3_b32 v4, v4, v235, s6 bitop3:0xa8
    v_cmp_ne_u32 vcc, 0, v4
    v_or_b32 v64, s6, v64
    v_or_b32 v65, s6, v65
    v_or_b32 v66, s6, v66
    v_or_b32 v67, s6, v67
    v_or_b32 v68, s6, v68
    v_or_b32 v69, s6, v69
    v_or_b32 v70, s6, v70
    v_or_b32 v71, s6, v71
    v_or_b32 v72, s6, v72
    v_or_b32 v73, s6, v73
    v_or_b32 v74, s6, v74
    v_or_b32 v75, s6, v75
    s_cbranch_vccnz L_cj3_r
L_cj3:
    v_mfma_f32_16x16x32_bf16 v[160:163], v[130:133], v[64:67], v[160:163]
    s_waitcnt vmcnt(3)
    v_bitop3_b32 v232, v80, v84, v144 bitop3:0x7e
    v_bitop3_b32 v233, v81, v85, v145 bitop3:0x7e
    v_mfma_f32_16x16x32_bf16 v[172:175], v[128:131], v[64:67], v[172:175]
    v_bitop3_b32 v234, v82, v86, v146 bitop3:0x7e
    v_bitop3_b32 v235, v83, v87, v147 bitop3:0x7e
    v_mfma_f32_16x16x32_bf16 v[164:167], v[130:133], v[68:71], v[164:167]
    v_bitop3_b32 v232, v232, v88, v144 bitop3:0xf6
    v_bitop3_b32 v233, v233, v89, v145 bitop3:0xf6
    v_mfma_f32_16x16x32_bf16 v[176:179], v[128:131], v[68:71], v[176:179]
    v_bitop3_b32 v234, v234, v90, v146 bitop3:0xf6
    v_bitop3_b32 v235, v235, v91, v147 bitop3:0xf6
    v_mfma_f32_16x16x32_bf16 v[168:171], v[130:133], v[72:75], v[168:171]
    v_or3_b32 v4, v232, v233, v234
    v_bitop3_b32 v4, v4, v235, s6 bitop3:0xa8
    v_mfma_f32_16x16x32_bf16 v[180:183], v[128:131], v[72:75], v[180:183]
    v_cmp_ne_u32 vcc, 0, v4
    v_or_b32 v80, s6, v80
    v_or_b32 v81, s6, v81
    v_or_b32 v82, s6, v82
    v_or_b32 v83, s6, v83
    v_or_b32 v84, s6, v84
    v_or_b32 v85, s6, v85
    v_or_b32 v86, s6, v86
    v_or_b32 v87, s6, v87
    v_or_b32 v88, s6, v88
    v_or_b32 v89, s6, v89
    v_or_b32 v90, s6, v90
    v_or_b32 v91, s6, v91
    s_cbranch_vccnz L_cj4_r
L_cj4:
    v_mfma_f32_16x16x32_bf16 v[160:163], v[130:133], v[80:83], v[160:163]
    v_mfma_f32_16x16x32_bf16 v[172:175], v[128:131], v[80:83], v[172:175]
    v_mfma_f32_16x16x32_bf16 v[164:167], v[130:133], v[84:87], v[164:167]
    v_mfma_f32_16x16x32_bf16 v[176:179], v[128:131], v[84:87], v[176:179]
    v_mfma_f32_16x16x32_bf16 v[168:171], v[130:133], v[88:91], v[168:171]
    v_mfma_f32_16x16x32_bf16 v[180:183], v[128:131], v[88:91], v[180:183]
    buffer_load_dwordx4 v[112:115], v12, s[64:67], s50 offen offset:0 sc1
    buffer_load_dwordx4 v[116:119], v12, s[64:67], s50 offen offset:1024 sc1
    buffer_load_dwordx4 v[120:123], v12, s[64:67], s50 offen offset:2048 sc1
    s_waitcnt vmcnt(3)
    v_bitop3_b32 v232, v96, v100, v144 bitop3:0x7e
    v_bitop3_b32 v233, v97, v101, v145 bitop3:0x7e
    v_bitop3_b32 v234, v98, v102, v146 bitop3:0x7e
    v_bitop3_b32 v235, v99, v103, v147 bitop3:0x7e
    v_bitop3_b32 v232, v232, v104, v144 bitop3:0xf6
    v_bitop3_b32 v233, v233, v105, v145 bitop3:0xf6
    v_bitop3_b32 v234, v234, v106, v146 bitop3:0xf6
    v_bitop3_b32 v235, v235, v107, v147 bitop3:0xf6
    v_or3_b32 v4, v232, v233, v234
    v_bitop3_b32 v4, v4, v235, s6 bitop3:0xa8
    v_cmp_ne_u32 vcc, 0, v4
    v_or_b32 v96, s6, v96
    v_or_b32 v97, s6, v97
    v_or_b32 v98, s6, v98
    v_or_b32 v99, s6, v99
    v_or_b32 v100, s6, v100
    v_or_b32 v101, s6, v101
    v_or_b32 v102, s6, v102
    v_or_b32 v103, s6, v103
    v_or_b32 v104, s6, v104
    v_or_b32 v105, s6, v105
    v_or_b32 v106, s6, v106
    v_or_b32 v107, s6, v107
    s_cbranch_vccnz L_cj5_r
L_cj5:
    v_mfma_f32_16x16x32_bf16 v[160:163], v[130:133], v[96:99], v[160:163]
    s_waitcnt vmcnt(0)
    v_bitop3_b32 v232, v112, v116, v144 bitop3:0x7e
    v_bitop3_b32 v233, v113, v117, v145 bitop3:0x7e
    v_mfma_f32_16x16x32_bf16 v[172:175], v[128:131], v[96:99], v[172:175]
    v_bitop3_b32 v234, v114, v118, v146 bitop3:0x7e
    v_bitop3_b32 v235, v115, v119, v147 bitop3:0x7e
    v_mfma_f32_16x16x32_bf16 v[164:167], v[130:133], v[100:103], v[164:167]
    v_bitop3_b32 v232, v232, v120, v144 bitop3:0xf6
    v_bitop3_b32 v233, v233, v121, v145 bitop3:0xf6
    v_mfma_f32_16x16x32_bf16 v[176:179], v[128:131], v[100:103], v[176:179]
    v_bitop3_b32 v234, v234, v122, v146 bitop3:0xf6
    v_bitop3_b32 v235, v235, v123, v147 bitop3:0xf6
    v_mfma_f32_16x16x32_bf16 v[168:171], v[130:133], v[104:107], v[168:171]
    v_or3_b32 v4, v232, v233, v234
    v_bitop3_b32 v4, v4, v235, s6 bitop3:0xa8
    v_mfma_f32_16x16x32_bf16 v[180:183], v[128:131], v[104:107], v[180:183]
    v_cmp_ne_u32 vcc, 0, v4
    v_or_b32 v112, s6, v112
    v_or_b32 v113, s6, v113
    v_or_b32 v114, s6, v114
    v_or_b32 v115, s6, v115
    v_or_b32 v116, s6, v116
    v_or_b32 v117, s6, v117
    v_or_b32 v118, s6, v118
    v_or_b32 v119, s6, v119
    v_or_b32 v120, s6, v120
    v_or_b32 v121, s6, v121
    v_or_b32 v122, s6, v122
    v_or_b32 v123, s6, v123
    s_cbranch_vccnz L_cj6_r
L_cj6:
    v_mfma_f32_16x16x32_bf16 v[160:163], v[130:133], v[112:115], v[160:163]
    v_mfma_f32_16x16x32_bf16 v[172:175], v[128:131], v[112:115], v[172:175]
    v_mfma_f32_16x16x32_bf16 v[164:167], v[130:133], v[116:119], v[164:167]
    v_mfma_f32_16x16x32_bf16 v[176:179], v[128:131], v[116:119], v[176:179]
    v_mfma_f32_16x16x32_bf16 v[168:171], v[130:133], v[120:123], v[168:171]
    v_mfma_f32_16x16x32_bf16 v[180:183], v[128:131], v[120:123], v[180:183]
    s_nop 2
    v_cvt_pk_bf16_f32 v184, v160, v161
    v_cvt_pk_bf16_f32 v186, v172, v173
    v_cvt_pk_bf16_f32 v185, v162, v163
    v_cvt_pk_bf16_f32 v187, v174, v175
    v_cvt_pk_bf16_f32 v188, v164, v165
    v_cvt_pk_bf16_f32 v190, v176, v177
    v_cvt_pk_bf16_f32 v189, v166, v167
    v_cvt_pk_bf16_f32 v191, v178, v179
    v_cvt_pk_bf16_f32 v192, v168, v169
    v_cvt_pk_bf16_f32 v194, v180, v181
    v_cvt_pk_bf16_f32 v193, v170, v171
    v_cvt_pk_bf16_f32 v195, v182, v183
    v_permlane16_swap_b32 v184, v186
    v_permlane16_swap_b32 v185, v187
    buffer_store_dwordx4 v[184:187], v3, s[32:35], s10 offen
    v_permlane16_swap_b32 v188, v190
    v_permlane16_swap_b32 v189, v191
    s_add_u32 s10, s10, 28672
    buffer_store_dwordx4 v[188:191], v3, s[32:35], s10 offen
    v_permlane16_swap_b32 v192, v194
    v_permlane16_swap_b32 v193, v195
    s_add_u32 s10, s10, 28672
    buffer_store_dwordx4 v[192:195], v3, s[32:35], s10 offen
    s_endpgm
L_cw:
    s_waitcnt vmcnt(0)
    s_barrier
    s_add_u32 m0, s8, 147456
    s_add_u32 s5, s12, 0
    buffer_load_dwordx4 v5, s[60:63], s5 offen offset:0 lds
    buffer_load_dwordx4 v6, s[60:63], s5 offen offset:1024 lds
    buffer_load_dwordx4 v7, s[60:63], s5 offen offset:2048 lds
    buffer_load_dwordx4 v8, s[60:63], s5 offen offset:3072 lds
    s_add_u32 m0, s8, 131072
    s_add_u32 s5, s12, 57344
    buffer_load_dwordx4 v5, s[60:63], s5 offen offset:0 lds
    buffer_load_dwordx4 v6, s[60:63], s5 offen offset:1024 lds
    s_add_u32 m0, s8, 131072
    s_add_u32 s5, s12, 57344
    buffer_load_dwordx4 v7, s[60:63], s5 offen offset:2048 lds
    buffer_load_dwordx4 v8, s[60:63], s5 offen offset:3072 lds
    s_add_u32 m0, s8, 114688
    s_add_u32 s5, s12, 114688
    buffer_load_dwordx4 v5, s[60:63], s5 offen offset:0 lds
    buffer_load_dwordx4 v6, s[60:63], s5 offen offset:1024 lds
    buffer_load_dwordx4 v7, s[60:63], s5 offen offset:2048 lds
    buffer_load_dwordx4 v8, s[60:63], s5 offen offset:3072 lds
    s_add_u32 m0, s8, 98304
    s_add_u32 s5, s12, 172032
    buffer_load_dwordx4 v5, s[60:63], s5 offen offset:0 lds
    buffer_load_dwordx4 v6, s[60:63], s5 offen offset:1024 lds
    buffer_load_dwordx4 v7, s[60:63], s5 offen offset:2048 lds
    buffer_load_dwordx4 v8, s[60:63], s5 offen offset:3072 lds
    s_add_u32 s12, s12, 128
    s_sub_u32 s5, s12, 896
    s_cmp_eq_u32 s5, s16
    s_cselect_b32 s12, s5, s12
    s_waitcnt vmcnt(0)
    s_barrier
    s_add_u32 m0, s8, 0
    s_add_u32 s5, s12, 0
    buffer_load_dwordx4 v5, s[60:63], s5 offen offset:0 lds
    buffer_load_dwordx4 v6, s[60:63], s5 offen offset:1024 lds
    buffer_load_dwordx4 v7, s[60:63], s5 offen offset:2048 lds
    buffer_load_dwordx4 v8, s[60:63], s5 offen offset:3072 lds
    s_add_u32 m0, s8, 16384
    s_add_u32 s5, s12, 57344
    buffer_load_dwordx4 v5, s[60:63], s5 offen offset:0 lds
    buffer_load_dwordx4 v6, s[60:63], s5 offen offset:1024 lds
    s_add_u32 m0, s8, 16384
    s_add_u32 s5, s12, 57344
    buffer_load_dwordx4 v7, s[60:63], s5 offen offset:2048 lds
    buffer_load_dwordx4 v8, s[60:63], s5 offen offset:3072 lds
    s_add_u32 m0, s8, 32768
    s_add_u32 s5, s12, 114688
    buffer_load_dwordx4 v5, s[60:63], s5 offen offset:0 lds
    buffer_load_dwordx4 v6, s[60:63], s5 offen offset:1024 lds
    buffer_load_dwordx4 v7, s[60:63], s5 offen offset:2048 lds
    buffer_load_dwordx4 v8, s[60:63], s5 offen offset:3072 lds
    s_add_u32 m0, s8, 49152
    s_add_u32 s5, s12, 172032
    buffer_load_dwordx4 v5, s[60:63], s5 offen offset:0 lds
    buffer_load_dwordx4 v6, s[60:63], s5 offen offset:1024 lds
    buffer_load_dwordx4 v7, s[60:63], s5 offen offset:2048 lds
    buffer_load_dwordx4 v8, s[60:63], s5 offen offset:3072 lds
    s_add_u32 s12, s12, 128
    s_sub_u32 s5, s12, 896
    s_cmp_eq_u32 s5, s16
    s_cselect_b32 s12, s5, s12
    s_waitcnt vmcnt(0)
    s_barrier
    buffer_store_dwordx2 v[152:153], v9, s[64:67], s13 offen sc1
    s_barrier
    ds_read2st64_b32 v[184:185], v10 offset0:0 offset1:1
    ds_read2st64_b32 v[186:187], v10 offset0:6 offset1:7
    ds_read2st64_b32 v[188:189], v10 offset0:2 offset1:3
    ds_read2st64_b32 v[190:191], v10 offset0:8 offset1:9
    ds_read2st64_b32 v[192:193], v10 offset0:4 offset1:5
    ds_read2st64_b32 v[194:195], v10 offset0:10 offset1:11
    ds_read_b128 v[208:211], v11 offset:0
    ds_read_b128 v[220:223], v11 offset:3072
    ds_read_b128 v[212:215], v11 offset:1024
    ds_read_b128 v[224:227], v11 offset:4096
    ds_read_b128 v[216:219], v11 offset:2048
    ds_read_b128 v[228:231], v11 offset:5120
    s_waitcnt lgkmcnt(5)
    v_mfma_f32_16x16x32_bf16 v[208:211], v[130:133], v[184:187], v[208:211]
    s_waitcnt lgkmcnt(4)
    v_mfma_f32_16x16x32_bf16 v[220:223], v[128:131], v[184:187], v[220:223]
    s_waitcnt lgkmcnt(3)
    v_mfma_f32_16x16x32_bf16 v[212:215], v[130:133], v[188:191], v[212:215]
    s_waitcnt lgkmcnt(2)
    v_mfma_f32_16x16x32_bf16 v[224:227], v[128:131], v[188:191], v[224:227]
    s_waitcnt lgkmcnt(1)
    v_mfma_f32_16x16x32_bf16 v[216:219], v[130:133], v[192:195], v[216:219]
    s_waitcnt lgkmcnt(0)
    v_mfma_f32_16x16x32_bf16 v[228:231], v[128:131], v[192:195], v[228:231]
    v_perm_b32 v16, v209, v208, s7
    v_perm_b32 v17, v211, v210, s7
    v_perm_b32 v18, v221, v220, s7
    v_perm_b32 v19, v223, v222, s7
    v_bfi_b32 v16, s6, v144, v16
    v_bfi_b32 v17, s6, v145, v17
    v_bfi_b32 v18, s6, v146, v18
    v_bfi_b32 v19, s6, v147, v19
    buffer_store_dwordx4 v[16:19], v12, s[64:67], s50 offen offset:0 sc1
    v_perm_b32 v20, v213, v212, s7
    v_perm_b32 v21, v215, v214, s7
    v_perm_b32 v22, v225, v224, s7
    v_perm_b32 v23, v227, v226, s7
    v_bfi_b32 v20, s6, v144, v20
    v_bfi_b32 v21, s6, v145, v21
    v_bfi_b32 v22, s6, v146, v22
    v_bfi_b32 v23, s6, v147, v23
    buffer_store_dwordx4 v[20:23], v12, s[64:67], s50 offen offset:1024 sc1
    v_perm_b32 v24, v217, v216, s7
    v_perm_b32 v25, v219, v218, s7
    v_perm_b32 v26, v229, v228, s7
    v_perm_b32 v27, v231, v230, s7
    v_bfi_b32 v24, s6, v144, v24
    v_bfi_b32 v25, s6, v145, v25
    v_bfi_b32 v26, s6, v146, v26
    v_bfi_b32 v27, s6, v147, v27
    buffer_store_dwordx4 v[24:27], v12, s[64:67], s50 offen offset:2048 sc1
    s_endpgm
L_yt0_r:
    buffer_load_dwordx4 v[16:19], v12, s[64:67], s44 offen offset:0 sc1
    buffer_load_dwordx4 v[20:23], v12, s[64:67], s44 offen offset:1024 sc1
    buffer_load_dwordx4 v[24:27], v12, s[64:67], s44 offen offset:2048 sc1
    s_sub_u32 s37, s37, 1
    s_cbranch_scc1 L_end
    s_waitcnt vmcnt(0)
    s_branch L_yt0
L_yt1_r:
    buffer_load_dwordx4 v[32:35], v12, s[64:67], s45 offen offset:0 sc1
    buffer_load_dwordx4 v[36:39], v12, s[64:67], s45 offen offset:1024 sc1
    buffer_load_dwordx4 v[40:43], v12, s[64:67], s45 offen offset:2048 sc1
    s_sub_u32 s37, s37, 1
    s_cbranch_scc1 L_end
    s_waitcnt vmcnt(0)
    s_branch L_yt1
L_at2_r:
    buffer_load_dwordx4 v[48:51], v12, s[64:67], s46 offen offset:0 sc1
    buffer_load_dwordx4 v[52:55], v12, s[64:67], s46 offen offset:1024 sc1
    buffer_load_dwordx4 v[56:59], v12, s[64:67], s46 offen offset:2048 sc1
    s_sub_u32 s37, s37, 1
    s_cbranch_scc1 L_end
    s_waitcnt vmcnt(0)
    s_branch L_at2
L_at6_r:
    buffer_load_dwordx4 v[112:115], v12, s[64:67], s50 offen offset:0 sc1
    buffer_load_dwordx4 v[116:119], v12, s[64:67], s50 offen offset:1024 sc1
    buffer_load_dwordx4 v[120:123], v12, s[64:67], s50 offen offset:2048 sc1
    s_sub_u32 s37, s37, 1
    s_cbranch_scc1 L_end
    s_waitcnt vmcnt(0)
    s_branch L_at6
L_ak_r:
    buffer_load_dwordx2 v[140:141], v2, s[64:67], s9 offen sc1
    s_sub_u32 s37, s37, 1
    s_cbranch_scc1 L_end
    s_waitcnt vmcnt(0)
    s_branch L_ak
L_aj3_r:
    buffer_load_dwordx4 v[64:67], v12, s[64:67], s47 offen offset:0 sc1
    buffer_load_dwordx4 v[68:71], v12, s[64:67], s47 offen offset:1024 sc1
    buffer_load_dwordx4 v[72:75], v12, s[64:67], s47 offen offset:2048 sc1
    s_sub_u32 s37, s37, 1
    s_cbranch_scc1 L_end
    s_waitcnt vmcnt(0)
    v_bitop3_b32 v232, v64, v68, v144 bitop3:0x7e
    v_bitop3_b32 v233, v65, v69, v145 bitop3:0x7e
    v_bitop3_b32 v234, v66, v70, v146 bitop3:0x7e
    v_bitop3_b32 v235, v67, v71, v147 bitop3:0x7e
    v_bitop3_b32 v232, v232, v72, v144 bitop3:0xf6
    v_bitop3_b32 v233, v233, v73, v145 bitop3:0xf6
    v_bitop3_b32 v234, v234, v74, v146 bitop3:0xf6
    v_bitop3_b32 v235, v235, v75, v147 bitop3:0xf6
    v_or3_b32 v4, v232, v233, v234
    v_bitop3_b32 v4, v4, v235, s6 bitop3:0xa8
    v_cmp_ne_u32 vcc, 0, v4
    v_or_b32 v64, s6, v64
    v_or_b32 v65, s6, v65
    v_or_b32 v66, s6, v66
    v_or_b32 v67, s6, v67
    v_or_b32 v68, s6, v68
    v_or_b32 v69, s6, v69
    v_or_b32 v70, s6, v70
    v_or_b32 v71, s6, v71
    v_or_b32 v72, s6, v72
    v_or_b32 v73, s6, v73
    v_or_b32 v74, s6, v74
    v_or_b32 v75, s6, v75
    s_cbranch_vccnz L_aj3_r
    s_nop 1
    s_branch L_aj3
L_aj4_r:
    buffer_load_dwordx4 v[80:83], v12, s[64:67], s48 offen offset:0 sc1
    buffer_load_dwordx4 v[84:87], v12, s[64:67], s48 offen offset:1024 sc1
    buffer_load_dwordx4 v[88:91], v12, s[64:67], s48 offen offset:2048 sc1
    s_sub_u32 s37, s37, 1
    s_cbranch_scc1 L_end
    s_waitcnt vmcnt(0)
    v_bitop3_b32 v232, v80, v84, v144 bitop3:0x7e
    v_bitop3_b32 v233, v81, v85, v145 bitop3:0x7e
    v_bitop3_b32 v234, v82, v86, v146 bitop3:0x7e
    v_bitop3_b32 v235, v83, v87, v147 bitop3:0x7e
    v_bitop3_b32 v232, v232, v88, v144 bitop3:0xf6
    v_bitop3_b32 v233, v233, v89, v145 bitop3:0xf6
    v_bitop3_b32 v234, v234, v90, v146 bitop3:0xf6
    v_bitop3_b32 v235, v235, v91, v147 bitop3:0xf6
    v_or3_b32 v4, v232, v233, v234
    v_bitop3_b32 v4, v4, v235, s6 bitop3:0xa8
    v_cmp_ne_u32 vcc, 0, v4
    v_or_b32 v80, s6, v80
    v_or_b32 v81, s6, v81
    v_or_b32 v82, s6, v82
    v_or_b32 v83, s6, v83
    v_or_b32 v84, s6, v84
    v_or_b32 v85, s6, v85
    v_or_b32 v86, s6, v86
    v_or_b32 v87, s6, v87
    v_or_b32 v88, s6, v88
    v_or_b32 v89, s6, v89
    v_or_b32 v90, s6, v90
    v_or_b32 v91, s6, v91
    s_cbranch_vccnz L_aj4_r
    s_nop 1
    s_branch L_aj4
L_aj5_r:
    buffer_load_dwordx4 v[96:99], v12, s[64:67], s49 offen offset:0 sc1
    buffer_load_dwordx4 v[100:103], v12, s[64:67], s49 offen offset:1024 sc1
    buffer_load_dwordx4 v[104:107], v12, s[64:67], s49 offen offset:2048 sc1
    s_sub_u32 s37, s37, 1
    s_cbranch_scc1 L_end
    s_waitcnt vmcnt(0)
    v_bitop3_b32 v232, v96, v100, v144 bitop3:0x7e
    v_bitop3_b32 v233, v97, v101, v145 bitop3:0x7e
    v_bitop3_b32 v234, v98, v102, v146 bitop3:0x7e
    v_bitop3_b32 v235, v99, v103, v147 bitop3:0x7e
    v_bitop3_b32 v232, v232, v104, v144 bitop3:0xf6
    v_bitop3_b32 v233, v233, v105, v145 bitop3:0xf6
    v_bitop3_b32 v234, v234, v106, v146 bitop3:0xf6
    v_bitop3_b32 v235, v235, v107, v147 bitop3:0xf6
    v_or3_b32 v4, v232, v233, v234
    v_bitop3_b32 v4, v4, v235, s6 bitop3:0xa8
    v_cmp_ne_u32 vcc, 0, v4
    v_or_b32 v96, s6, v96
    v_or_b32 v97, s6, v97
    v_or_b32 v98, s6, v98
    v_or_b32 v99, s6, v99
    v_or_b32 v100, s6, v100
    v_or_b32 v101, s6, v101
    v_or_b32 v102, s6, v102
    v_or_b32 v103, s6, v103
    v_or_b32 v104, s6, v104
    v_or_b32 v105, s6, v105
    v_or_b32 v106, s6, v106
    v_or_b32 v107, s6, v107
    s_cbranch_vccnz L_aj5_r
    s_nop 1
    s_branch L_aj5
L_bt2_r:
    buffer_load_dwordx4 v[48:51], v12, s[64:67], s46 offen offset:0 sc1
    buffer_load_dwordx4 v[52:55], v12, s[64:67], s46 offen offset:1024 sc1
    buffer_load_dwordx4 v[56:59], v12, s[64:67], s46 offen offset:2048 sc1
    s_sub_u32 s37, s37, 1
    s_cbranch_scc1 L_end
    s_waitcnt vmcnt(0)
    s_branch L_bt2
L_bk_r:
    buffer_load_dwordx2 v[140:141], v2, s[64:67], s9 offen sc1
    s_sub_u32 s37, s37, 1
    s_cbranch_scc1 L_end
    s_waitcnt vmcnt(0)
    s_branch L_bk
L_bj3_r:
    buffer_load_dwordx4 v[64:67], v12, s[64:67], s47 offen offset:0 sc1
    buffer_load_dwordx4 v[68:71], v12, s[64:67], s47 offen offset:1024 sc1
    buffer_load_dwordx4 v[72:75], v12, s[64:67], s47 offen offset:2048 sc1
    s_sub_u32 s37, s37, 1
    s_cbranch_scc1 L_end
    s_waitcnt vmcnt(0)
    v_bitop3_b32 v232, v64, v68, v144 bitop3:0x7e
    v_bitop3_b32 v233, v65, v69, v145 bitop3:0x7e
    v_bitop3_b32 v234, v66, v70, v146 bitop3:0x7e
    v_bitop3_b32 v235, v67, v71, v147 bitop3:0x7e
    v_bitop3_b32 v232, v232, v72, v144 bitop3:0xf6
    v_bitop3_b32 v233, v233, v73, v145 bitop3:0xf6
    v_bitop3_b32 v234, v234, v74, v146 bitop3:0xf6
    v_bitop3_b32 v235, v235, v75, v147 bitop3:0xf6
    v_or3_b32 v4, v232, v233, v234
    v_bitop3_b32 v4, v4, v235, s6 bitop3:0xa8
    v_cmp_ne_u32 vcc, 0, v4
    v_or_b32 v64, s6, v64
    v_or_b32 v65, s6, v65
    v_or_b32 v66, s6, v66
    v_or_b32 v67, s6, v67
    v_or_b32 v68, s6, v68
    v_or_b32 v69, s6, v69
    v_or_b32 v70, s6, v70
    v_or_b32 v71, s6, v71
    v_or_b32 v72, s6, v72
    v_or_b32 v73, s6, v73
    v_or_b32 v74, s6, v74
    v_or_b32 v75, s6, v75
    s_cbranch_vccnz L_bj3_r
    s_nop 1
    s_branch L_bj3
L_bj4_r:
    buffer_load_dwordx4 v[80:83], v12, s[64:67], s48 offen offset:0 sc1
    buffer_load_dwordx4 v[84:87], v12, s[64:67], s48 offen offset:1024 sc1
    buffer_load_dwordx4 v[88:91], v12, s[64:67], s48 offen offset:2048 sc1
    s_sub_u32 s37, s37, 1
    s_cbranch_scc1 L_end
    s_waitcnt vmcnt(0)
    v_bitop3_b32 v232, v80, v84, v144 bitop3:0x7e
    v_bitop3_b32 v233, v81, v85, v145 bitop3:0x7e
    v_bitop3_b32 v234, v82, v86, v146 bitop3:0x7e
    v_bitop3_b32 v235, v83, v87, v147 bitop3:0x7e
    v_bitop3_b32 v232, v232, v88, v144 bitop3:0xf6
    v_bitop3_b32 v233, v233, v89, v145 bitop3:0xf6
    v_bitop3_b32 v234, v234, v90, v146 bitop3:0xf6
    v_bitop3_b32 v235, v235, v91, v147 bitop3:0xf6
    v_or3_b32 v4, v232, v233, v234
    v_bitop3_b32 v4, v4, v235, s6 bitop3:0xa8
    v_cmp_ne_u32 vcc, 0, v4
    v_or_b32 v80, s6, v80
    v_or_b32 v81, s6, v81
    v_or_b32 v82, s6, v82
    v_or_b32 v83, s6, v83
    v_or_b32 v84, s6, v84
    v_or_b32 v85, s6, v85
    v_or_b32 v86, s6, v86
    v_or_b32 v87, s6, v87
    v_or_b32 v88, s6, v88
    v_or_b32 v89, s6, v89
    v_or_b32 v90, s6, v90
    v_or_b32 v91, s6, v91
    s_cbranch_vccnz L_bj4_r
    s_nop 1
    s_branch L_bj4
L_bj5_r:
    buffer_load_dwordx4 v[96:99], v12, s[64:67], s49 offen offset:0 sc1
    buffer_load_dwordx4 v[100:103], v12, s[64:67], s49 offen offset:1024 sc1
    buffer_load_dwordx4 v[104:107], v12, s[64:67], s49 offen offset:2048 sc1
    s_sub_u32 s37, s37, 1
    s_cbranch_scc1 L_end
    s_waitcnt vmcnt(0)
    v_bitop3_b32 v232, v96, v100, v144 bitop3:0x7e
    v_bitop3_b32 v233, v97, v101, v145 bitop3:0x7e
    v_bitop3_b32 v234, v98, v102, v146 bitop3:0x7e
    v_bitop3_b32 v235, v99, v103, v147 bitop3:0x7e
    v_bitop3_b32 v232, v232, v104, v144 bitop3:0xf6
    v_bitop3_b32 v233, v233, v105, v145 bitop3:0xf6
    v_bitop3_b32 v234, v234, v106, v146 bitop3:0xf6
    v_bitop3_b32 v235, v235, v107, v147 bitop3:0xf6
    v_or3_b32 v4, v232, v233, v234
    v_bitop3_b32 v4, v4, v235, s6 bitop3:0xa8
    v_cmp_ne_u32 vcc, 0, v4
    v_or_b32 v96, s6, v96
    v_or_b32 v97, s6, v97
    v_or_b32 v98, s6, v98
    v_or_b32 v99, s6, v99
    v_or_b32 v100, s6, v100
    v_or_b32 v101, s6, v101
    v_or_b32 v102, s6, v102
    v_or_b32 v103, s6, v103
    v_or_b32 v104, s6, v104
    v_or_b32 v105, s6, v105
    v_or_b32 v106, s6, v106
    v_or_b32 v107, s6, v107
    s_cbranch_vccnz L_bj5_r
    s_nop 1
    s_branch L_bj5
L_bj6_r:
    buffer_load_dwordx4 v[112:115], v12, s[64:67], s50 offen offset:0 sc1
    buffer_load_dwordx4 v[116:119], v12, s[64:67], s50 offen offset:1024 sc1
    buffer_load_dwordx4 v[120:123], v12, s[64:67], s50 offen offset:2048 sc1
    s_sub_u32 s37, s37, 1
    s_cbranch_scc1 L_end
    s_waitcnt vmcnt(0)
    v_bitop3_b32 v232, v112, v116, v144 bitop3:0x7e
    v_bitop3_b32 v233, v113, v117, v145 bitop3:0x7e
    v_bitop3_b32 v234, v114, v118, v146 bitop3:0x7e
    v_bitop3_b32 v235, v115, v119, v147 bitop3:0x7e
    v_bitop3_b32 v232, v232, v120, v144 bitop3:0xf6
    v_bitop3_b32 v233, v233, v121, v145 bitop3:0xf6
    v_bitop3_b32 v234, v234, v122, v146 bitop3:0xf6
    v_bitop3_b32 v235, v235, v123, v147 bitop3:0xf6
    v_or3_b32 v4, v232, v233, v234
    v_bitop3_b32 v4, v4, v235, s6 bitop3:0xa8
    v_cmp_ne_u32 vcc, 0, v4
    v_or_b32 v112, s6, v112
    v_or_b32 v113, s6, v113
    v_or_b32 v114, s6, v114
    v_or_b32 v115, s6, v115
    v_or_b32 v116, s6, v116
    v_or_b32 v117, s6, v117
    v_or_b32 v118, s6, v118
    v_or_b32 v119, s6, v119
    v_or_b32 v120, s6, v120
    v_or_b32 v121, s6, v121
    v_or_b32 v122, s6, v122
    v_or_b32 v123, s6, v123
    s_cbranch_vccnz L_bj6_r
    s_nop 1
    s_branch L_bj6
L_ct2_r:
    buffer_load_dwordx4 v[48:51], v12, s[64:67], s46 offen offset:0 sc1
    buffer_load_dwordx4 v[52:55], v12, s[64:67], s46 offen offset:1024 sc1
    buffer_load_dwordx4 v[56:59], v12, s[64:67], s46 offen offset:2048 sc1
    s_sub_u32 s37, s37, 1
    s_cbranch_scc1 L_end
    s_waitcnt vmcnt(0)
    s_branch L_ct2
L_ck_r:
    buffer_load_dwordx2 v[140:141], v2, s[64:67], s9 offen sc1
    s_sub_u32 s37, s37, 1
    s_cbranch_scc1 L_end
    s_waitcnt vmcnt(0)
    s_branch L_ck
L_cj3_r:
    buffer_load_dwordx4 v[64:67], v12, s[64:67], s47 offen offset:0 sc1
    buffer_load_dwordx4 v[68:71], v12, s[64:67], s47 offen offset:1024 sc1
    buffer_load_dwordx4 v[72:75], v12, s[64:67], s47 offen offset:2048 sc1
    s_sub_u32 s37, s37, 1
    s_cbranch_scc1 L_end
    s_waitcnt vmcnt(0)
    v_bitop3_b32 v232, v64, v68, v144 bitop3:0x7e
    v_bitop3_b32 v233, v65, v69, v145 bitop3:0x7e
    v_bitop3_b32 v234, v66, v70, v146 bitop3:0x7e
    v_bitop3_b32 v235, v67, v71, v147 bitop3:0x7e
    v_bitop3_b32 v232, v232, v72, v144 bitop3:0xf6
    v_bitop3_b32 v233, v233, v73, v145 bitop3:0xf6
    v_bitop3_b32 v234, v234, v74, v146 bitop3:0xf6
    v_bitop3_b32 v235, v235, v75, v147 bitop3:0xf6
    v_or3_b32 v4, v232, v233, v234
    v_bitop3_b32 v4, v4, v235, s6 bitop3:0xa8
    v_cmp_ne_u32 vcc, 0, v4
    v_or_b32 v64, s6, v64
    v_or_b32 v65, s6, v65
    v_or_b32 v66, s6, v66
    v_or_b32 v67, s6, v67
    v_or_b32 v68, s6, v68
    v_or_b32 v69, s6, v69
    v_or_b32 v70, s6, v70
    v_or_b32 v71, s6, v71
    v_or_b32 v72, s6, v72
    v_or_b32 v73, s6, v73
    v_or_b32 v74, s6, v74
    v_or_b32 v75, s6, v75
    s_cbranch_vccnz L_cj3_r
    s_nop 1
    s_branch L_cj3
L_cj4_r:
    buffer_load_dwordx4 v[80:83], v12, s[64:67], s48 offen offset:0 sc1
    buffer_load_dwordx4 v[84:87], v12, s[64:67], s48 offen offset:1024 sc1
    buffer_load_dwordx4 v[88:91], v12, s[64:67], s48 offen offset:2048 sc1
    s_sub_u32 s37, s37, 1
    s_cbranch_scc1 L_end
    s_waitcnt vmcnt(0)
    v_bitop3_b32 v232, v80, v84, v144 bitop3:0x7e
    v_bitop3_b32 v233, v81, v85, v145 bitop3:0x7e
    v_bitop3_b32 v234, v82, v86, v146 bitop3:0x7e
    v_bitop3_b32 v235, v83, v87, v147 bitop3:0x7e
    v_bitop3_b32 v232, v232, v88, v144 bitop3:0xf6
    v_bitop3_b32 v233, v233, v89, v145 bitop3:0xf6
    v_bitop3_b32 v234, v234, v90, v146 bitop3:0xf6
    v_bitop3_b32 v235, v235, v91, v147 bitop3:0xf6
    v_or3_b32 v4, v232, v233, v234
    v_bitop3_b32 v4, v4, v235, s6 bitop3:0xa8
    v_cmp_ne_u32 vcc, 0, v4
    v_or_b32 v80, s6, v80
    v_or_b32 v81, s6, v81
    v_or_b32 v82, s6, v82
    v_or_b32 v83, s6, v83
    v_or_b32 v84, s6, v84
    v_or_b32 v85, s6, v85
    v_or_b32 v86, s6, v86
    v_or_b32 v87, s6, v87
    v_or_b32 v88, s6, v88
    v_or_b32 v89, s6, v89
    v_or_b32 v90, s6, v90
    v_or_b32 v91, s6, v91
    s_cbranch_vccnz L_cj4_r
    s_nop 1
    s_branch L_cj4
L_cj5_r:
    buffer_load_dwordx4 v[96:99], v12, s[64:67], s49 offen offset:0 sc1
    buffer_load_dwordx4 v[100:103], v12, s[64:67], s49 offen offset:1024 sc1
    buffer_load_dwordx4 v[104:107], v12, s[64:67], s49 offen offset:2048 sc1
    s_sub_u32 s37, s37, 1
    s_cbranch_scc1 L_end
    s_waitcnt vmcnt(0)
    v_bitop3_b32 v232, v96, v100, v144 bitop3:0x7e
    v_bitop3_b32 v233, v97, v101, v145 bitop3:0x7e
    v_bitop3_b32 v234, v98, v102, v146 bitop3:0x7e
    v_bitop3_b32 v235, v99, v103, v147 bitop3:0x7e
    v_bitop3_b32 v232, v232, v104, v144 bitop3:0xf6
    v_bitop3_b32 v233, v233, v105, v145 bitop3:0xf6
    v_bitop3_b32 v234, v234, v106, v146 bitop3:0xf6
    v_bitop3_b32 v235, v235, v107, v147 bitop3:0xf6
    v_or3_b32 v4, v232, v233, v234
    v_bitop3_b32 v4, v4, v235, s6 bitop3:0xa8
    v_cmp_ne_u32 vcc, 0, v4
    v_or_b32 v96, s6, v96
    v_or_b32 v97, s6, v97
    v_or_b32 v98, s6, v98
    v_or_b32 v99, s6, v99
    v_or_b32 v100, s6, v100
    v_or_b32 v101, s6, v101
    v_or_b32 v102, s6, v102
    v_or_b32 v103, s6, v103
    v_or_b32 v104, s6, v104
    v_or_b32 v105, s6, v105
    v_or_b32 v106, s6, v106
    v_or_b32 v107, s6, v107
    s_cbranch_vccnz L_cj5_r
    s_nop 1
    s_branch L_cj5
L_cj6_r:
    buffer_load_dwordx4 v[112:115], v12, s[64:67], s50 offen offset:0 sc1
    buffer_load_dwordx4 v[116:119], v12, s[64:67], s50 offen offset:1024 sc1
    buffer_load_dwordx4 v[120:123], v12, s[64:67], s50 offen offset:2048 sc1
    s_sub_u32 s37, s37, 1
    s_cbranch_scc1 L_end
    s_waitcnt vmcnt(0)
    v_bitop3_b32 v232, v112, v116, v144 bitop3:0x7e
    v_bitop3_b32 v233, v113, v117, v145 bitop3:0x7e
    v_bitop3_b32 v234, v114, v118, v146 bitop3:0x7e
    v_bitop3_b32 v235, v115, v119, v147 bitop3:0x7e
    v_bitop3_b32 v232, v232, v120, v144 bitop3:0xf6
    v_bitop3_b32 v233, v233, v121, v145 bitop3:0xf6
    v_bitop3_b32 v234, v234, v122, v146 bitop3:0xf6
    v_bitop3_b32 v235, v235, v123, v147 bitop3:0xf6
    v_or3_b32 v4, v232, v233, v234
    v_bitop3_b32 v4, v4, v235, s6 bitop3:0xa8
    v_cmp_ne_u32 vcc, 0, v4
    v_or_b32 v112, s6, v112
    v_or_b32 v113, s6, v113
    v_or_b32 v114, s6, v114
    v_or_b32 v115, s6, v115
    v_or_b32 v116, s6, v116
    v_or_b32 v117, s6, v117
    v_or_b32 v118, s6, v118
    v_or_b32 v119, s6, v119
    v_or_b32 v120, s6, v120
    v_or_b32 v121, s6, v121
    v_or_b32 v122, s6, v122
    v_or_b32 v123, s6, v123
    s_cbranch_vccnz L_cj6_r
    s_nop 1
    s_branch L_cj6
L_nsl:
    buffer_load_dwordx2 v[152:153], v156, s[24:27], s21 offen sc1
    s_sub_u32 s37, s37, 1
    s_cbranch_scc1 L_end
    s_waitcnt vmcnt(0)
    v_cmp_eq_u32 vcc, 0, v153
    s_cbranch_vccnz L_nsl
    s_branch L_nbk
L_C:
    s_lshr_b32 s68, s3, 1
    s_and_b32 s69, s3, 1
    v_lshrrev_b32 v1, 5, v0
    v_lshlrev_b32 v1, 10, v1
    v_bfe_u32 v7, v0, 2, 3
    v_lshl_or_b32 v1, v7, 7, v1
    v_bfe_u32 v7, v0, 3, 2
    v_lshl_or_b32 v1, v7, 5, v1
    v_and_b32 v7, 3, v0
    v_lshl_or_b32 v1, v7, 3, v1
    s_lshl_b32 s4, s68, 13
    v_add_u32 v1, s4, v1
    v_xor_b32 v2, 32, v1
    v_xor_b32 v3, 64, v1
    v_xor_b32 v4, 96, v1
    v_bfe_u32 v5, v0, 3, 1
    v_lshlrev_b32 v5, 10, v5
    v_and_b32 v7, 7, v0
    v_lshl_or_b32 v5, v7, 7, v5
    v_lshrrev_b32 v7, 5, v0
    v_bfe_u32 v6, v0, 1, 2
    v_xor_b32 v7, v7, v6
    v_lshl_or_b32 v5, v7, 5, v5
    v_bfe_u32 v7, v0, 4, 1
    v_lshl_or_b32 v5, v7, 4, v5
    s_mul_i32 s4, s69, 6144
    s_add_u32 s4, s4, 65536
    v_add_u32 v5, s4, v5
    v_xor_b32 v6, 64, v5
    v_bfe_u32 v7, v0, 3, 1
    v_lshlrev_b32 v7, 10, v7
    v_and_b32 v8, 7, v0
    v_lshl_or_b32 v7, v8, 7, v7
    v_bfe_u32 v8, v0, 5, 1
    v_bfe_u32 v9, v0, 1, 1
    v_xor_b32 v8, v8, v9
    v_lshl_or_b32 v7, v8, 4, v7
    v_bfe_u32 v8, v0, 4, 1
    v_lshl_or_b32 v7, v8, 5, v7
    v_bfe_u32 v8, v0, 2, 1
    v_lshl_or_b32 v7, v8, 6, v7
    s_mul_i32 s4, s68, 12288
    s_add_u32 s4, s4, 65536
    v_add_u32 v7, s4, v7
    v_mov_b32 v8, 0
    v_mov_b32 v9, 0
    v_mov_b32 v10, 0
    v_mov_b32 v11, 0
    s_nop 1
    v_mfma_f32_32x32x16_bf16 v[24:39], v[8:11], v[8:11], 0
    v_mfma_f32_32x32x16_bf16 v[48:63], v[8:11], v[8:11], 0
    v_mfma_f32_32x32x16_bf16 v[64:79], v[8:11], v[8:11], 0
    v_mfma_f32_32x32x16_bf16 v[80:95], v[8:11], v[8:11], 0
    v_mfma_f32_32x32x16_bf16 v[96:111], v[8:11], v[8:11], 0
    v_mfma_f32_32x32x16_bf16 v[112:127], v[8:11], v[8:11], 0
    v_mfma_f32_32x32x16_bf16 v[128:143], v[8:11], v[8:11], 0
    v_mfma_f32_32x32x16_bf16 v[144:159], v[8:11], v[8:11], 0
    v_mfma_f32_32x32x16_bf16 v[160:175], v[8:11], v[8:11], 0
    v_mfma_f32_32x32x16_bf16 v[176:191], v[8:11], v[8:11], 0
    v_mfma_f32_32x32x16_bf16 v[192:207], v[8:11], v[8:11], 0
    v_mfma_f32_32x32x16_bf16 v[208:223], v[8:11], v[8:11], 0
    v_mfma_f32_32x32x16_bf16 v[224:239], v[8:11], v[8:11], 0
    v_mfma_f32_32x32x16_bf16 v[240:255], v[8:11], v[8:11], 0
    s_nop 15
    s_mov_b32 s5, 12288
    s_mov_b32 s6, 0
    s_waitcnt lgkmcnt(0)
    s_branch L_p1e
L_p1:
    s_barrier
    ds_read_b64_tr_b16 v[8:9], v1 offset:49152
    ds_read_b64_tr_b16 v[10:11], v1 offset:51200
    v_mfma_f32_16x16x32_bf16 v[124:127], v[28:31], v[52:55], v[124:127]
    ds_read_b64_tr_b16 v[12:13], v2 offset:49152
    ds_read_b64_tr_b16 v[14:15], v2 offset:51200
    v_mfma_f32_16x16x32_bf16 v[128:131], v[28:31], v[56:59], v[128:131]
    ds_read_b64_tr_b16 v[16:17], v3 offset:49152
    v_mfma_f32_16x16x32_bf16 v[132:135], v[28:31], v[60:63], v[132:135]
    ds_read_b64_tr_b16 v[18:19], v3 offset:51200
    v_mfma_f32_16x16x32_bf16 v[136:139], v[32:35], v[52:55], v[136:139]
    ds_read_b64_tr_b16 v[20:21], v4 offset:49152
    ds_read_b64_tr_b16 v[22:23], v4 offset:51200
    v_mfma_f32_16x16x32_bf16 v[140:143], v[32:35], v[56:59], v[140:143]
    ds_read_b64_tr_b16 v[24:25], v1 offset:53248
    v_mfma_f32_16x16x32_bf16 v[144:147], v[32:35], v[60:63], v[144:147]
    ds_read_b64_tr_b16 v[26:27], v1 offset:55296
    v_mfma_f32_16x16x32_bf16 v[148:151], v[36:39], v[52:55], v[148:151]
    ds_read_b64_tr_b16 v[28:29], v2 offset:53248
    ds_read_b64_tr_b16 v[30:31], v2 offset:55296
    v_mfma_f32_16x16x32_bf16 v[152:155], v[36:39], v[56:59], v[152:155]
    ds_read_b64_tr_b16 v[32:33], v3 offset:53248
    v_mfma_f32_16x16x32_bf16 v[156:159], v[36:39], v[60:63], v[156:159]
    ds_read_b64_tr_b16 v[34:35], v3 offset:55296
    s_waitcnt lgkmcnt(12)
    v_mfma_f32_16x16x32_bf16 v[160:163], v[8:11], v[52:55], v[160:163]
    ds_read_b64_tr_b16 v[36:37], v4 offset:53248
    ds_read_b64_tr_b16 v[38:39], v4 offset:55296
    v_mfma_f32_16x16x32_bf16 v[164:167], v[8:11], v[56:59], v[164:167]
    v_mfma_f32_16x16x32_bf16 v[168:171], v[8:11], v[60:63], v[168:171]
    s_waitcnt lgkmcnt(12)
    v_mfma_f32_16x16x32_bf16 v[172:175], v[12:15], v[52:55], v[172:175]
    v_mfma_f32_16x16x32_bf16 v[176:179], v[12:15], v[56:59], v[176:179]
    v_mfma_f32_16x16x32_bf16 v[180:183], v[12:15], v[60:63], v[180:183]
    s_waitcnt lgkmcnt(10)
    v_mfma_f32_16x16x32_bf16 v[184:187], v[16:19], v[52:55], v[184:187]
    v_mfma_f32_16x16x32_bf16 v[188:191], v[16:19], v[56:59], v[188:191]
    v_mfma_f32_16x16x32_bf16 v[192:195], v[16:19], v[60:63], v[192:195]
    s_waitcnt lgkmcnt(8)
    v_mfma_f32_16x16x32_bf16 v[196:199], v[20:23], v[52:55], v[196:199]
    v_mfma_f32_16x16x32_bf16 v[200:203], v[20:23], v[56:59], v[200:203]
    v_mfma_f32_16x16x32_bf16 v[204:207], v[20:23], v[60:63], v[204:207]
    s_waitcnt lgkmcnt(6)
    v_mfma_f32_16x16x32_bf16 v[208:211], v[24:27], v[52:55], v[208:211]
    v_mfma_f32_16x16x32_bf16 v[212:215], v[24:27], v[56:59], v[212:215]
    v_mfma_f32_16x16x32_bf16 v[216:219], v[24:27], v[60:63], v[216:219]
    s_waitcnt lgkmcnt(0)
L_p1e:
    s_barrier
    ds_read_b64_tr_b16 v[8:9], v1 offset:0
    ds_read_b64_tr_b16 v[10:11], v1 offset:2048
    v_mfma_f32_16x16x32_bf16 v[220:223], v[28:31], v[52:55], v[220:223]
    ds_read_b128 v[40:43], v5 offset:0
    ds_read_b128 v[44:47], v5 offset:2048
    v_mfma_f32_16x16x32_bf16 v[224:227], v[28:31], v[56:59], v[224:227]
    ds_read_b128 v[48:51], v5 offset:4096
    v_mfma_f32_16x16x32_bf16 v[228:231], v[28:31], v[60:63], v[228:231]
    ds_read_b64_tr_b16 v[12:13], v2 offset:0
    v_mfma_f32_16x16x32_bf16 v[232:235], v[32:35], v[52:55], v[232:235]
    ds_read_b64_tr_b16 v[14:15], v2 offset:2048
    ds_read_b64_tr_b16 v[16:17], v3 offset:0
    v_mfma_f32_16x16x32_bf16 v[236:239], v[32:35], v[56:59], v[236:239]
    ds_read_b64_tr_b16 v[18:19], v3 offset:2048
    v_mfma_f32_16x16x32_bf16 v[240:243], v[32:35], v[60:63], v[240:243]
    ds_read_b64_tr_b16 v[20:21], v4 offset:0
    v_mfma_f32_16x16x32_bf16 v[244:247], v[36:39], v[52:55], v[244:247]
    ds_read_b64_tr_b16 v[22:23], v4 offset:2048
    ds_read_b64_tr_b16 v[24:25], v1 offset:4096
    v_mfma_f32_16x16x32_bf16 v[248:251], v[36:39], v[56:59], v[248:251]
    ds_read_b64_tr_b16 v[26:27], v1 offset:6144
    v_mfma_f32_16x16x32_bf16 v[252:255], v[36:39], v[60:63], v[252:255]
    ds_read_b64_tr_b16 v[28:29], v2 offset:4096
    s_waitcnt lgkmcnt(12)
    s_waitcnt lgkmcnt(11)
    v_mfma_f32_16x16x32_bf16 v[64:67], v[8:11], v[40:43], v[64:67]
    ds_read_b64_tr_b16 v[30:31], v2 offset:6144
    ds_read_b64_tr_b16 v[32:33], v3 offset:4096
    s_waitcnt lgkmcnt(12)
    v_mfma_f32_16x16x32_bf16 v[68:71], v[8:11], v[44:47], v[68:71]
    ds_read_b64_tr_b16 v[34:35], v3 offset:6144
    s_waitcnt lgkmcnt(12)
    v_mfma_f32_16x16x32_bf16 v[72:75], v[8:11], v[48:51], v[72:75]
    ds_read_b64_tr_b16 v[36:37], v4 offset:4096
    s_waitcnt lgkmcnt(11)
    v_mfma_f32_16x16x32_bf16 v[76:79], v[12:15], v[40:43], v[76:79]
    ds_read_b64_tr_b16 v[38:39], v4 offset:6144
    v_mfma_f32_16x16x32_bf16 v[80:83], v[12:15], v[44:47], v[80:83]
    v_mfma_f32_16x16x32_bf16 v[84:87], v[12:15], v[48:51], v[84:87]
    s_waitcnt lgkmcnt(10)
    v_mfma_f32_16x16x32_bf16 v[88:91], v[16:19], v[40:43], v[88:91]
    v_mfma_f32_16x16x32_bf16 v[92:95], v[16:19], v[44:47], v[92:95]
    v_mfma_f32_16x16x32_bf16 v[96:99], v[16:19], v[48:51], v[96:99]
    s_waitcnt lgkmcnt(8)
    v_mfma_f32_16x16x32_bf16 v[100:103], v[20:23], v[40:43], v[100:103]
    v_mfma_f32_16x16x32_bf16 v[104:107], v[20:23], v[44:47], v[104:107]
    v_mfma_f32_16x16x32_bf16 v[108:111], v[20:23], v[48:51], v[108:111]
    s_waitcnt lgkmcnt(6)
    v_mfma_f32_16x16x32_bf16 v[112:115], v[24:27], v[40:43], v[112:115]
    v_mfma_f32_16x16x32_bf16 v[116:119], v[24:27], v[44:47], v[116:119]
    v_mfma_f32_16x16x32_bf16 v[120:123], v[24:27], v[48:51], v[120:123]
    s_waitcnt lgkmcnt(0)
    s_barrier
    ds_read_b64_tr_b16 v[8:9], v1 offset:16384
    ds_read_b64_tr_b16 v[10:11], v1 offset:18432
    v_mfma_f32_16x16x32_bf16 v[124:127], v[28:31], v[40:43], v[124:127]
    ds_read_b64_tr_b16 v[12:13], v2 offset:16384
    ds_read_b64_tr_b16 v[14:15], v2 offset:18432
    v_mfma_f32_16x16x32_bf16 v[128:131], v[28:31], v[44:47], v[128:131]
    ds_read_b64_tr_b16 v[16:17], v3 offset:16384
    v_mfma_f32_16x16x32_bf16 v[132:135], v[28:31], v[48:51], v[132:135]
    ds_read_b64_tr_b16 v[18:19], v3 offset:18432
    v_mfma_f32_16x16x32_bf16 v[136:139], v[32:35], v[40:43], v[136:139]
    ds_read_b64_tr_b16 v[20:21], v4 offset:16384
    ds_read_b64_tr_b16 v[22:23], v4 offset:18432
    v_mfma_f32_16x16x32_bf16 v[140:143], v[32:35], v[44:47], v[140:143]
    ds_read_b64_tr_b16 v[24:25], v1 offset:20480
    v_mfma_f32_16x16x32_bf16 v[144:147], v[32:35], v[48:51], v[144:147]
    ds_read_b64_tr_b16 v[26:27], v1 offset:22528
    v_mfma_f32_16x16x32_bf16 v[148:151], v[36:39], v[40:43], v[148:151]
    ds_read_b64_tr_b16 v[28:29], v2 offset:20480
    ds_read_b64_tr_b16 v[30:31], v2 offset:22528
    v_mfma_f32_16x16x32_bf16 v[152:155], v[36:39], v[44:47], v[152:155]
    ds_read_b64_tr_b16 v[32:33], v3 offset:20480
    v_mfma_f32_16x16x32_bf16 v[156:159], v[36:39], v[48:51], v[156:159]
    ds_read_b64_tr_b16 v[34:35], v3 offset:22528
    s_waitcnt lgkmcnt(12)
    v_mfma_f32_16x16x32_bf16 v[160:163], v[8:11], v[40:43], v[160:163]
    ds_read_b64_tr_b16 v[36:37], v4 offset:20480
    ds_read_b64_tr_b16 v[38:39], v4 offset:22528
    v_mfma_f32_16x16x32_bf16 v[164:167], v[8:11], v[44:47], v[164:167]
    v_mfma_f32_16x16x32_bf16 v[168:171], v[8:11], v[48:51], v[168:171]
    s_waitcnt lgkmcnt(12)
    v_mfma_f32_16x16x32_bf16 v[172:175], v[12:15], v[40:43], v[172:175]
    v_mfma_f32_16x16x32_bf16 v[176:179], v[12:15], v[44:47], v[176:179]
    v_mfma_f32_16x16x32_bf16 v[180:183], v[12:15], v[48:51], v[180:183]
    s_waitcnt lgkmcnt(10)
    v_mfma_f32_16x16x32_bf16 v[184:187], v[16:19], v[40:43], v[184:187]
    v_mfma_f32_16x16x32_bf16 v[188:191], v[16:19], v[44:47], v[188:191]
    v_mfma_f32_16x16x32_bf16 v[192:195], v[16:19], v[48:51], v[192:195]
    s_waitcnt lgkmcnt(8)
    v_mfma_f32_16x16x32_bf16 v[196:199], v[20:23], v[40:43], v[196:199]
    v_mfma_f32_16x16x32_bf16 v[200:203], v[20:23], v[44:47], v[200:203]
    v_mfma_f32_16x16x32_bf16 v[204:207], v[20:23], v[48:51], v[204:207]
    s_waitcnt lgkmcnt(6)
    v_mfma_f32_16x16x32_bf16 v[208:211], v[24:27], v[40:43], v[208:211]
    v_mfma_f32_16x16x32_bf16 v[212:215], v[24:27], v[44:47], v[212:215]
    v_mfma_f32_16x16x32_bf16 v[216:219], v[24:27], v[48:51], v[216:219]
    s_waitcnt lgkmcnt(0)
    s_barrier
    ds_read_b64_tr_b16 v[8:9], v1 offset:32768
    ds_read_b64_tr_b16 v[10:11], v1 offset:34816
    v_mfma_f32_16x16x32_bf16 v[220:223], v[28:31], v[40:43], v[220:223]
    ds_read_b128 v[52:55], v6 offset:0
    ds_read_b128 v[56:59], v6 offset:2048
    v_mfma_f32_16x16x32_bf16 v[224:227], v[28:31], v[44:47], v[224:227]
    ds_read_b128 v[60:63], v6 offset:4096
    v_mfma_f32_16x16x32_bf16 v[228:231], v[28:31], v[48:51], v[228:231]
    ds_read_b64_tr_b16 v[12:13], v2 offset:32768
    v_mfma_f32_16x16x32_bf16 v[232:235], v[32:35], v[40:43], v[232:235]
    ds_read_b64_tr_b16 v[14:15], v2 offset:34816
    ds_read_b64_tr_b16 v[16:17], v3 offset:32768
    v_mfma_f32_16x16x32_bf16 v[236:239], v[32:35], v[44:47], v[236:239]
    ds_read_b64_tr_b16 v[18:19], v3 offset:34816
    v_mfma_f32_16x16x32_bf16 v[240:243], v[32:35], v[48:51], v[240:243]
    ds_read_b64_tr_b16 v[20:21], v4 offset:32768
    v_mfma_f32_16x16x32_bf16 v[244:247], v[36:39], v[40:43], v[244:247]
    ds_read_b64_tr_b16 v[22:23], v4 offset:34816
    ds_read_b64_tr_b16 v[24:25], v1 offset:36864
    v_mfma_f32_16x16x32_bf16 v[248:251], v[36:39], v[44:47], v[248:251]
    ds_read_b64_tr_b16 v[26:27], v1 offset:38912
    v_mfma_f32_16x16x32_bf16 v[252:255], v[36:39], v[48:51], v[252:255]
    ds_read_b64_tr_b16 v[28:29], v2 offset:36864
    s_waitcnt lgkmcnt(12)
    s_waitcnt lgkmcnt(11)
    v_mfma_f32_16x16x32_bf16 v[64:67], v[8:11], v[52:55], v[64:67]
    ds_read_b64_tr_b16 v[30:31], v2 offset:38912
    ds_read_b64_tr_b16 v[32:33], v3 offset:36864
    s_waitcnt lgkmcnt(12)
    v_mfma_f32_16x16x32_bf16 v[68:71], v[8:11], v[56:59], v[68:71]
    ds_read_b64_tr_b16 v[34:35], v3 offset:38912
    s_waitcnt lgkmcnt(12)
    v_mfma_f32_16x16x32_bf16 v[72:75], v[8:11], v[60:63], v[72:75]
    ds_read_b64_tr_b16 v[36:37], v4 offset:36864
    s_waitcnt lgkmcnt(11)
    v_mfma_f32_16x16x32_bf16 v[76:79], v[12:15], v[52:55], v[76:79]
    ds_read_b64_tr_b16 v[38:39], v4 offset:38912
    v_mfma_f32_16x16x32_bf16 v[80:83], v[12:15], v[56:59], v[80:83]
    v_mfma_f32_16x16x32_bf16 v[84:87], v[12:15], v[60:63], v[84:87]
    s_waitcnt lgkmcnt(10)
    v_mfma_f32_16x16x32_bf16 v[88:91], v[16:19], v[52:55], v[88:91]
    v_mfma_f32_16x16x32_bf16 v[92:95], v[16:19], v[56:59], v[92:95]
    v_mfma_f32_16x16x32_bf16 v[96:99], v[16:19], v[60:63], v[96:99]
    s_waitcnt lgkmcnt(8)
    v_mfma_f32_16x16x32_bf16 v[100:103], v[20:23], v[52:55], v[100:103]
    v_mfma_f32_16x16x32_bf16 v[104:107], v[20:23], v[56:59], v[104:107]
    v_mfma_f32_16x16x32_bf16 v[108:111], v[20:23], v[60:63], v[108:111]
    s_waitcnt lgkmcnt(6)
    v_mfma_f32_16x16x32_bf16 v[112:115], v[24:27], v[52:55], v[112:115]
    v_mfma_f32_16x16x32_bf16 v[116:119], v[24:27], v[56:59], v[116:119]
    v_mfma_f32_16x16x32_bf16 v[120:123], v[24:27], v[60:63], v[120:123]
    s_waitcnt lgkmcnt(0)
    v_add_u32 v5, s5, v5
    v_add_u32 v6, s5, v6
    s_sub_u32 s5, 0, s5
    s_add_u32 s6, s6, 1
    s_cmp_lt_u32 s6, 7
    s_cbranch_scc1 L_p1
    v_xor_b32 v5, 64, v7
    v_add_u32 v6, 49152, v7
    v_cvt_pk_bf16_f32 v64, v64, v65
    v_cvt_pk_bf16_f32 v65, v66, v67
    v_cvt_pk_bf16_f32 v66, v76, v77
    v_cvt_pk_bf16_f32 v67, v78, v79
    v_cvt_pk_bf16_f32 v68, v68, v69
    v_cvt_pk_bf16_f32 v69, v70, v71
    v_cvt_pk_bf16_f32 v70, v80, v81
    v_cvt_pk_bf16_f32 v71, v82, v83
    v_cvt_pk_bf16_f32 v72, v72, v73
    v_cvt_pk_bf16_f32 v73, v74, v75
    v_cvt_pk_bf16_f32 v74, v84, v85
    v_cvt_pk_bf16_f32 v75, v86, v87
    v_permlane16_swap_b32 v64, v66
    v_permlane16_swap_b32 v65, v67
    v_permlane16_swap_b32 v68, v70
    v_permlane16_swap_b32 v69, v71
    v_permlane16_swap_b32 v72, v74
    v_permlane16_swap_b32 v73, v75
    s_barrier
    ds_read_b64_tr_b16 v[8:9], v1 offset:49152
    ds_read_b64_tr_b16 v[10:11], v1 offset:51200
    v_mfma_f32_16x16x32_bf16 v[124:127], v[28:31], v[52:55], v[124:127]
    ds_read_b64_tr_b16 v[12:13], v2 offset:49152
    ds_read_b64_tr_b16 v[14:15], v2 offset:51200
    v_cvt_pk_bf16_f32 v88, v88, v89
    v_cvt_pk_bf16_f32 v89, v90, v91
    v_mfma_f32_16x16x32_bf16 v[128:131], v[28:31], v[56:59], v[128:131]
    ds_read_b64_tr_b16 v[16:17], v3 offset:49152
    v_cvt_pk_bf16_f32 v90, v100, v101
    v_cvt_pk_bf16_f32 v91, v102, v103
    v_mfma_f32_16x16x32_bf16 v[132:135], v[28:31], v[60:63], v[132:135]
    ds_read_b64_tr_b16 v[18:19], v3 offset:51200
    v_cvt_pk_bf16_f32 v92, v92, v93
    v_cvt_pk_bf16_f32 v93, v94, v95
    v_mfma_f32_16x16x32_bf16 v[136:139], v[32:35], v[52:55], v[136:139]
    ds_read_b64_tr_b16 v[20:21], v4 offset:49152
    ds_read_b64_tr_b16 v[22:23], v4 offset:51200
    v_cvt_pk_bf16_f32 v94, v104, v105
    v_cvt_pk_bf16_f32 v95, v106, v107
    v_mfma_f32_16x16x32_bf16 v[140:143], v[32:35], v[56:59], v[140:143]
    ds_read_b64_tr_b16 v[24:25], v1 offset:53248
    v_cvt_pk_bf16_f32 v96, v96, v97
    v_cvt_pk_bf16_f32 v97, v98, v99
    v_mfma_f32_16x16x32_bf16 v[144:147], v[32:35], v[60:63], v[144:147]
    ds_read_b64_tr_b16 v[26:27], v1 offset:55296
    v_cvt_pk_bf16_f32 v98, v108, v109
    v_cvt_pk_bf16_f32 v99, v110, v111
    v_mfma_f32_16x16x32_bf16 v[148:151], v[36:39], v[52:55], v[148:151]
    ds_read_b64_tr_b16 v[28:29], v2 offset:53248
    ds_read_b64_tr_b16 v[30:31], v2 offset:55296
    v_permlane16_swap_b32 v88, v90
    v_mfma_f32_16x16x32_bf16 v[152:155], v[36:39], v[56:59], v[152:155]
    ds_read_b64_tr_b16 v[32:33], v3 offset:53248
    v_permlane16_swap_b32 v89, v91
    v_mfma_f32_16x16x32_bf16 v[156:159], v[36:39], v[60:63], v[156:159]
    ds_read_b64_tr_b16 v[34:35], v3 offset:55296
    v_permlane16_swap_b32 v92, v94
    s_waitcnt lgkmcnt(12)
    v_mfma_f32_16x16x32_bf16 v[160:163], v[8:11], v[52:55], v[160:163]
    ds_read_b64_tr_b16 v[36:37], v4 offset:53248
    ds_read_b64_tr_b16 v[38:39], v4 offset:55296
    v_permlane16_swap_b32 v93, v95
    v_mfma_f32_16x16x32_bf16 v[164:167], v[8:11], v[56:59], v[164:167]
    v_permlane16_swap_b32 v96, v98
    v_mfma_f32_16x16x32_bf16 v[168:171], v[8:11], v[60:63], v[168:171]
    v_permlane16_swap_b32 v97, v99
    s_waitcnt lgkmcnt(12)
    v_mfma_f32_16x16x32_bf16 v[172:175], v[12:15], v[52:55], v[172:175]
    v_cvt_pk_bf16_f32 v112, v112, v113
    v_cvt_pk_bf16_f32 v113, v114, v115
    v_mfma_f32_16x16x32_bf16 v[176:179], v[12:15], v[56:59], v[176:179]
    v_cvt_pk_bf16_f32 v114, v124, v125
    v_cvt_pk_bf16_f32 v115, v126, v127
    v_mfma_f32_16x16x32_bf16 v[180:183], v[12:15], v[60:63], v[180:183]
    v_cvt_pk_bf16_f32 v116, v116, v117
    v_cvt_pk_bf16_f32 v117, v118, v119
    s_waitcnt lgkmcnt(10)
    v_mfma_f32_16x16x32_bf16 v[184:187], v[16:19], v[52:55], v[184:187]
    v_cvt_pk_bf16_f32 v118, v128, v129
    v_cvt_pk_bf16_f32 v119, v130, v131
    v_mfma_f32_16x16x32_bf16 v[188:191], v[16:19], v[56:59], v[188:191]
    v_cvt_pk_bf16_f32 v120, v120, v121
    v_cvt_pk_bf16_f32 v121, v122, v123
    v_mfma_f32_16x16x32_bf16 v[192:195], v[16:19], v[60:63], v[192:195]
    v_cvt_pk_bf16_f32 v122, v132, v133
    v_cvt_pk_bf16_f32 v123, v134, v135
    s_waitcnt lgkmcnt(8)
    v_mfma_f32_16x16x32_bf16 v[196:199], v[20:23], v[52:55], v[196:199]
    v_permlane16_swap_b32 v112, v114
    v_mfma_f32_16x16x32_bf16 v[200:203], v[20:23], v[56:59], v[200:203]
    v_permlane16_swap_b32 v113, v115
    v_mfma_f32_16x16x32_bf16 v[204:207], v[20:23], v[60:63], v[204:207]
    v_permlane16_swap_b32 v116, v118
    s_waitcnt lgkmcnt(6)
    v_mfma_f32_16x16x32_bf16 v[208:211], v[24:27], v[52:55], v[208:211]
    v_permlane16_swap_b32 v117, v119
    v_mfma_f32_16x16x32_bf16 v[212:215], v[24:27], v[56:59], v[212:215]
    v_permlane16_swap_b32 v120, v122
    v_mfma_f32_16x16x32_bf16 v[216:219], v[24:27], v[60:63], v[216:219]
    v_permlane16_swap_b32 v121, v123
    s_waitcnt lgkmcnt(0)
    s_barrier
    ds_read_b128 v[8:11], v7 offset:24576
    ds_read_b128 v[12:15], v7 offset:26624
    v_mfma_f32_16x16x32_bf16 v[220:223], v[28:31], v[52:55], v[220:223]
    ds_read_b128 v[16:19], v7 offset:28672
    v_cvt_pk_bf16_f32 v136, v136, v137
    v_cvt_pk_bf16_f32 v137, v138, v139
    v_mfma_f32_16x16x32_bf16 v[224:227], v[28:31], v[56:59], v[224:227]
    ds_read_b128 v[20:23], v7 offset:30720
    v_cvt_pk_bf16_f32 v138, v148, v149
    v_cvt_pk_bf16_f32 v139, v150, v151
    v_mfma_f32_16x16x32_bf16 v[228:231], v[28:31], v[60:63], v[228:231]
    ds_read_b128 v[24:27], v7 offset:32768
    v_cvt_pk_bf16_f32 v140, v140, v141
    v_cvt_pk_bf16_f32 v141, v142, v143
    v_mfma_f32_16x16x32_bf16 v[232:235], v[32:35], v[52:55], v[232:235]
    ds_read_b128 v[28:31], v7 offset:34816
    v_cvt_pk_bf16_f32 v142, v152, v153
    v_cvt_pk_bf16_f32 v143, v154, v155
    v_mfma_f32_16x16x32_bf16 v[236:239], v[32:35], v[56:59], v[236:239]
    v_cvt_pk_bf16_f32 v144, v144, v145
    v_cvt_pk_bf16_f32 v145, v146, v147
    v_mfma_f32_16x16x32_bf16 v[240:243], v[32:35], v[60:63], v[240:243]
    v_cvt_pk_bf16_f32 v146, v156, v157
    v_cvt_pk_bf16_f32 v147, v158, v159
    v_mfma_f32_16x16x32_bf16 v[244:247], v[36:39], v[52:55], v[244:247]
    v_permlane16_swap_b32 v136, v138
    v_mfma_f32_16x16x32_bf16 v[248:251], v[36:39], v[56:59], v[248:251]
    v_permlane16_swap_b32 v137, v139
    v_mfma_f32_16x16x32_bf16 v[252:255], v[36:39], v[60:63], v[252:255]
    v_permlane16_swap_b32 v140, v142
    s_waitcnt lgkmcnt(5)
    v_mfma_f32_16x16x32_bf16 v[40:43], v[8:11], v[64:67], 0
    ds_read_b128 v[32:35], v5 offset:24576
    v_permlane16_swap_b32 v141, v143
    v_mfma_f32_16x16x32_bf16 v[44:47], v[8:11], v[68:71], 0
    v_permlane16_swap_b32 v144, v146
    v_mfma_f32_16x16x32_bf16 v[48:51], v[8:11], v[72:75], 0
    v_permlane16_swap_b32 v145, v147
    s_waitcnt lgkmcnt(5)
    v_mfma_f32_16x16x32_bf16 v[76:79], v[12:15], v[64:67], 0
    ds_read_b128 v[36:39], v5 offset:26624
    v_add_u32 v4, 49152, v5
    v_cvt_pk_bf16_f32 v160, v160, v161
    v_mfma_f32_16x16x32_bf16 v[80:83], v[12:15], v[68:71], 0
    v_cvt_pk_bf16_f32 v161, v162, v163
    v_cvt_pk_bf16_f32 v162, v172, v173
    v_mfma_f32_16x16x32_bf16 v[84:87], v[12:15], v[72:75], 0
    v_cvt_pk_bf16_f32 v163, v174, v175
    v_cvt_pk_bf16_f32 v164, v164, v165
    s_waitcnt lgkmcnt(5)
    v_mfma_f32_16x16x32_bf16 v[100:103], v[16:19], v[64:67], 0
    ds_read_b128 v[8:11], v5 offset:28672
    v_cvt_pk_bf16_f32 v165, v166, v167
    v_cvt_pk_bf16_f32 v166, v176, v177
    v_mfma_f32_16x16x32_bf16 v[104:107], v[16:19], v[68:71], 0
    v_cvt_pk_bf16_f32 v167, v178, v179
    v_cvt_pk_bf16_f32 v168, v168, v169
    v_mfma_f32_16x16x32_bf16 v[108:111], v[16:19], v[72:75], 0
    v_cvt_pk_bf16_f32 v169, v170, v171
    v_cvt_pk_bf16_f32 v170, v180, v181
    s_waitcnt lgkmcnt(5)
    v_mfma_f32_16x16x32_bf16 v[124:127], v[20:23], v[64:67], 0
    ds_read_b128 v[12:15], v5 offset:30720
    v_cvt_pk_bf16_f32 v171, v182, v183
    v_cvt_pk_bf16_f32 v184, v184, v185
    v_mfma_f32_16x16x32_bf16 v[128:131], v[20:23], v[68:71], 0
    v_permlane16_swap_b32 v160, v162
    v_mfma_f32_16x16x32_bf16 v[132:135], v[20:23], v[72:75], 0
    v_permlane16_swap_b32 v161, v163
    s_waitcnt lgkmcnt(5)
    v_mfma_f32_16x16x32_bf16 v[52:55], v[24:27], v[64:67], 0
    ds_read_b128 v[16:19], v5 offset:32768
    v_permlane16_swap_b32 v164, v166
    v_mfma_f32_16x16x32_bf16 v[56:59], v[24:27], v[68:71], 0
    v_permlane16_swap_b32 v165, v167
    v_mfma_f32_16x16x32_bf16 v[60:63], v[24:27], v[72:75], 0
    v_permlane16_swap_b32 v168, v170
    s_waitcnt lgkmcnt(5)
    v_mfma_f32_16x16x32_bf16 v[148:151], v[28:31], v[64:67], 0
    ds_read_b128 v[20:23], v5 offset:34816
    v_permlane16_swap_b32 v169, v171
    v_mfma_f32_16x16x32_bf16 v[152:155], v[28:31], v[68:71], 0
    v_cvt_pk_bf16_f32 v185, v186, v187
    v_cvt_pk_bf16_f32 v186, v196, v197
    v_mfma_f32_16x16x32_bf16 v[156:159], v[28:31], v[72:75], 0
    v_cvt_pk_bf16_f32 v187, v198, v199
    v_cvt_pk_bf16_f32 v188, v188, v189
    s_waitcnt lgkmcnt(5)
    v_mfma_f32_16x16x32_bf16 v[40:43], v[32:35], v[88:91], v[40:43]
    ds_read_b128 v[24:27], v6 offset:0
    v_cvt_pk_bf16_f32 v189, v190, v191
    v_cvt_pk_bf16_f32 v190, v200, v201
    v_mfma_f32_16x16x32_bf16 v[44:47], v[32:35], v[92:95], v[44:47]
    v_cvt_pk_bf16_f32 v191, v202, v203
    v_cvt_pk_bf16_f32 v192, v192, v193
    v_mfma_f32_16x16x32_bf16 v[48:51], v[32:35], v[96:99], v[48:51]
    v_cvt_pk_bf16_f32 v193, v194, v195
    v_cvt_pk_bf16_f32 v194, v204, v205
    s_waitcnt lgkmcnt(5)
    v_mfma_f32_16x16x32_bf16 v[76:79], v[36:39], v[88:91], v[76:79]
    ds_read_b128 v[28:31], v6 offset:2048
    v_cvt_pk_bf16_f32 v195, v206, v207
    v_cvt_pk_bf16_f32 v208, v208, v209
    v_mfma_f32_16x16x32_bf16 v[80:83], v[36:39], v[92:95], v[80:83]
    v_permlane16_swap_b32 v184, v186
    v_mfma_f32_16x16x32_bf16 v[84:87], v[36:39], v[96:99], v[84:87]
    v_permlane16_swap_b32 v185, v187
    s_waitcnt lgkmcnt(5)
    v_mfma_f32_16x16x32_bf16 v[100:103], v[8:11], v[88:91], v[100:103]
    ds_read_b128 v[32:35], v6 offset:4096
    v_permlane16_swap_b32 v188, v190
    v_mfma_f32_16x16x32_bf16 v[104:107], v[8:11], v[92:95], v[104:107]
    v_permlane16_swap_b32 v189, v191
    v_mfma_f32_16x16x32_bf16 v[108:111], v[8:11], v[96:99], v[108:111]
    v_permlane16_swap_b32 v192, v194
    s_waitcnt lgkmcnt(5)
    v_mfma_f32_16x16x32_bf16 v[124:127], v[12:15], v[88:91], v[124:127]
    ds_read_b128 v[36:39], v6 offset:6144
    v_permlane16_swap_b32 v193, v195
    v_mfma_f32_16x16x32_bf16 v[128:131], v[12:15], v[92:95], v[128:131]
    v_cvt_pk_bf16_f32 v209, v210, v211
    v_cvt_pk_bf16_f32 v210, v220, v221
    v_mfma_f32_16x16x32_bf16 v[132:135], v[12:15], v[96:99], v[132:135]
    v_cvt_pk_bf16_f32 v211, v222, v223
    v_cvt_pk_bf16_f32 v212, v212, v213
    s_waitcnt lgkmcnt(5)
    v_mfma_f32_16x16x32_bf16 v[52:55], v[16:19], v[88:91], v[52:55]
    ds_read_b128 v[8:11], v6 offset:8192
    v_cvt_pk_bf16_f32 v213, v214, v215
    v_cvt_pk_bf16_f32 v214, v224, v225
    v_mfma_f32_16x16x32_bf16 v[56:59], v[16:19], v[92:95], v[56:59]
    v_cvt_pk_bf16_f32 v215, v226, v227
    v_cvt_pk_bf16_f32 v216, v216, v217
    v_mfma_f32_16x16x32_bf16 v[60:63], v[16:19], v[96:99], v[60:63]
    v_cvt_pk_bf16_f32 v217, v218, v219
    v_cvt_pk_bf16_f32 v218, v228, v229
    s_waitcnt lgkmcnt(5)
    v_mfma_f32_16x16x32_bf16 v[148:151], v[20:23], v[88:91], v[148:151]
    ds_read_b128 v[12:15], v6 offset:10240
    v_cvt_pk_bf16_f32 v219, v230, v231
    v_cvt_pk_bf16_f32 v232, v232, v233
    v_mfma_f32_16x16x32_bf16 v[152:155], v[20:23], v[92:95], v[152:155]
    v_permlane16_swap_b32 v208, v210
    v_mfma_f32_16x16x32_bf16 v[156:159], v[20:23], v[96:99], v[156:159]
    v_permlane16_swap_b32 v209, v211
    s_waitcnt lgkmcnt(5)
    v_mfma_f32_16x16x32_bf16 v[40:43], v[24:27], v[112:115], v[40:43]
    ds_read_b128 v[16:19], v4 offset:0
    v_permlane16_swap_b32 v212, v214
    v_mfma_f32_16x16x32_bf16 v[44:47], v[24:27], v[116:119], v[44:47]
    v_permlane16_swap_b32 v213, v215
    v_mfma_f32_16x16x32_bf16 v[48:51], v[24:27], v[120:123], v[48:51]
    v_permlane16_swap_b32 v216, v218
    s_waitcnt lgkmcnt(5)
    v_mfma_f32_16x16x32_bf16 v[76:79], v[28:31], v[112:115], v[76:79]
    ds_read_b128 v[20:23], v4 offset:2048
    v_permlane16_swap_b32 v217, v219
    v_mfma_f32_16x16x32_bf16 v[80:83], v[28:31], v[116:119], v[80:83]
    v_cvt_pk_bf16_f32 v233, v234, v235
    v_cvt_pk_bf16_f32 v234, v244, v245
    v_mfma_f32_16x16x32_bf16 v[84:87], v[28:31], v[120:123], v[84:87]
    v_cvt_pk_bf16_f32 v235, v246, v247
    v_cvt_pk_bf16_f32 v236, v236, v237
    s_waitcnt lgkmcnt(5)
    v_mfma_f32_16x16x32_bf16 v[100:103], v[32:35], v[112:115], v[100:103]
    ds_read_b128 v[24:27], v4 offset:4096
    v_cvt_pk_bf16_f32 v237, v238, v239
    v_cvt_pk_bf16_f32 v238, v248, v249
    v_mfma_f32_16x16x32_bf16 v[104:107], v[32:35], v[116:119], v[104:107]
    v_cvt_pk_bf16_f32 v239, v250, v251
    v_cvt_pk_bf16_f32 v240, v240, v241
    v_mfma_f32_16x16x32_bf16 v[108:111], v[32:35], v[120:123], v[108:111]
    v_cvt_pk_bf16_f32 v241, v242, v243
    v_cvt_pk_bf16_f32 v242, v252, v253
    s_waitcnt lgkmcnt(5)
    v_mfma_f32_16x16x32_bf16 v[124:127], v[36:39], v[112:115], v[124:127]
    ds_read_b128 v[28:31], v4 offset:6144
    v_cvt_pk_bf16_f32 v243, v254, v255
    v_mfma_f32_16x16x32_bf16 v[128:131], v[36:39], v[116:119], v[128:131]
    v_permlane16_swap_b32 v232, v234
    v_mfma_f32_16x16x32_bf16 v[132:135], v[36:39], v[120:123], v[132:135]
    v_permlane16_swap_b32 v233, v235
    s_waitcnt lgkmcnt(5)
    v_mfma_f32_16x16x32_bf16 v[52:55], v[8:11], v[112:115], v[52:55]
    ds_read_b128 v[32:35], v4 offset:8192
    v_permlane16_swap_b32 v236, v238
    v_mfma_f32_16x16x32_bf16 v[56:59], v[8:11], v[116:119], v[56:59]
    v_permlane16_swap_b32 v237, v239
    v_mfma_f32_16x16x32_bf16 v[60:63], v[8:11], v[120:123], v[60:63]
    v_permlane16_swap_b32 v240, v242
    s_waitcnt lgkmcnt(5)
    v_mfma_f32_16x16x32_bf16 v[148:151], v[12:15], v[112:115], v[148:151]
    ds_read_b128 v[36:39], v4 offset:10240
    v_permlane16_swap_b32 v241, v243
    v_mfma_f32_16x16x32_bf16 v[152:155], v[12:15], v[116:119], v[152:155]
    v_mfma_f32_16x16x32_bf16 v[156:159], v[12:15], v[120:123], v[156:159]
    s_barrier
    s_waitcnt lgkmcnt(5)
    v_mfma_f32_16x16x32_bf16 v[40:43], v[16:19], v[136:139], v[40:43]
    ds_read_b128 v[8:11], v6 offset:24576
    v_mfma_f32_16x16x32_bf16 v[44:47], v[16:19], v[140:143], v[44:47]
    v_mfma_f32_16x16x32_bf16 v[48:51], v[16:19], v[144:147], v[48:51]
    s_waitcnt lgkmcnt(5)
    v_mfma_f32_16x16x32_bf16 v[76:79], v[20:23], v[136:139], v[76:79]
    ds_read_b128 v[12:15], v6 offset:26624
    v_mfma_f32_16x16x32_bf16 v[80:83], v[20:23], v[140:143], v[80:83]
    v_mfma_f32_16x16x32_bf16 v[84:87], v[20:23], v[144:147], v[84:87]
    s_waitcnt lgkmcnt(5)
    v_mfma_f32_16x16x32_bf16 v[100:103], v[24:27], v[136:139], v[100:103]
    ds_read_b128 v[16:19], v6 offset:28672
    v_mfma_f32_16x16x32_bf16 v[104:107], v[24:27], v[140:143], v[104:107]
    v_mfma_f32_16x16x32_bf16 v[108:111], v[24:27], v[144:147], v[108:111]
    s_waitcnt lgkmcnt(5)
    v_mfma_f32_16x16x32_bf16 v[124:127], v[28:31], v[136:139], v[124:127]
    ds_read_b128 v[20:23], v6 offset:30720
    v_mfma_f32_16x16x32_bf16 v[128:131], v[28:31], v[140:143], v[128:131]
    v_mfma_f32_16x16x32_bf16 v[132:135], v[28:31], v[144:147], v[132:135]
    s_waitcnt lgkmcnt(5)
    v_mfma_f32_16x16x32_bf16 v[52:55], v[32:35], v[136:139], v[52:55]
    ds_read_b128 v[24:27], v6 offset:32768
    v_mfma_f32_16x16x32_bf16 v[56:59], v[32:35], v[140:143], v[56:59]
    v_mfma_f32_16x16x32_bf16 v[60:63], v[32:35], v[144:147], v[60:63]
    s_waitcnt lgkmcnt(5)
    v_mfma_f32_16x16x32_bf16 v[148:151], v[36:39], v[136:139], v[148:151]
    ds_read_b128 v[28:31], v6 offset:34816
    v_mfma_f32_16x16x32_bf16 v[152:155], v[36:39], v[140:143], v[152:155]
    v_mfma_f32_16x16x32_bf16 v[156:159], v[36:39], v[144:147], v[156:159]
    s_waitcnt lgkmcnt(5)
    v_mfma_f32_16x16x32_bf16 v[40:43], v[8:11], v[160:163], v[40:43]
    ds_read_b128 v[32:35], v4 offset:24576
    v_mfma_f32_16x16x32_bf16 v[44:47], v[8:11], v[164:167], v[44:47]
    v_mfma_f32_16x16x32_bf16 v[48:51], v[8:11], v[168:171], v[48:51]
    s_waitcnt lgkmcnt(5)
    v_mfma_f32_16x16x32_bf16 v[76:79], v[12:15], v[160:163], v[76:79]
    ds_read_b128 v[36:39], v4 offset:26624
    v_mfma_f32_16x16x32_bf16 v[80:83], v[12:15], v[164:167], v[80:83]
    v_mfma_f32_16x16x32_bf16 v[84:87], v[12:15], v[168:171], v[84:87]
    s_waitcnt lgkmcnt(5)
    v_mfma_f32_16x16x32_bf16 v[100:103], v[16:19], v[160:163], v[100:103]
    ds_read_b128 v[8:11], v4 offset:28672
    v_mfma_f32_16x16x32_bf16 v[104:107], v[16:19], v[164:167], v[104:107]
    v_mfma_f32_16x16x32_bf16 v[108:111], v[16:19], v[168:171], v[108:111]
    s_waitcnt lgkmcnt(5)
    v_mfma_f32_16x16x32_bf16 v[124:127], v[20:23], v[160:163], v[124:127]
    ds_read_b128 v[12:15], v4 offset:30720
    v_mfma_f32_16x16x32_bf16 v[128:131], v[20:23], v[164:167], v[128:131]
    v_mfma_f32_16x16x32_bf16 v[132:135], v[20:23], v[168:171], v[132:135]
    s_waitcnt lgkmcnt(5)
    v_mfma_f32_16x16x32_bf16 v[52:55], v[24:27], v[160:163], v[52:55]
    ds_read_b128 v[16:19], v4 offset:32768
    v_mfma_f32_16x16x32_bf16 v[56:59], v[24:27], v[164:167], v[56:59]
    v_mfma_f32_16x16x32_bf16 v[60:63], v[24:27], v[168:171], v[60:63]
    s_waitcnt lgkmcnt(5)
    v_mfma_f32_16x16x32_bf16 v[148:151], v[28:31], v[160:163], v[148:151]
    ds_read_b128 v[20:23], v4 offset:34816
    v_mfma_f32_16x16x32_bf16 v[152:155], v[28:31], v[164:167], v[152:155]
    v_mfma_f32_16x16x32_bf16 v[156:159], v[28:31], v[168:171], v[156:159]
    s_waitcnt lgkmcnt(5)
    v_mfma_f32_16x16x32_bf16 v[40:43], v[32:35], v[184:187], v[40:43]
    ds_read_b128 v[24:27], v7 offset:0
    v_mfma_f32_16x16x32_bf16 v[44:47], v[32:35], v[188:191], v[44:47]
    v_mfma_f32_16x16x32_bf16 v[48:51], v[32:35], v[192:195], v[48:51]
    s_waitcnt lgkmcnt(5)
    v_mfma_f32_16x16x32_bf16 v[76:79], v[36:39], v[184:187], v[76:79]
    ds_read_b128 v[28:31], v7 offset:2048
    v_mfma_f32_16x16x32_bf16 v[80:83], v[36:39], v[188:191], v[80:83]
    v_mfma_f32_16x16x32_bf16 v[84:87], v[36:39], v[192:195], v[84:87]
    s_waitcnt lgkmcnt(5)
    v_mfma_f32_16x16x32_bf16 v[100:103], v[8:11], v[184:187], v[100:103]
    ds_read_b128 v[32:35], v7 offset:4096
    v_mfma_f32_16x16x32_bf16 v[104:107], v[8:11], v[188:191], v[104:107]
    v_mfma_f32_16x16x32_bf16 v[108:111], v[8:11], v[192:195], v[108:111]
    s_waitcnt lgkmcnt(5)
    v_mfma_f32_16x16x32_bf16 v[124:127], v[12:15], v[184:187], v[124:127]
    ds_read_b128 v[36:39], v7 offset:6144
    v_mfma_f32_16x16x32_bf16 v[128:131], v[12:15], v[188:191], v[128:131]
    v_mfma_f32_16x16x32_bf16 v[132:135], v[12:15], v[192:195], v[132:135]
    s_waitcnt lgkmcnt(5)
    v_mfma_f32_16x16x32_bf16 v[52:55], v[16:19], v[184:187], v[52:55]
    ds_read_b128 v[8:11], v7 offset:8192
    v_mfma_f32_16x16x32_bf16 v[56:59], v[16:19], v[188:191], v[56:59]
    v_mfma_f32_16x16x32_bf16 v[60:63], v[16:19], v[192:195], v[60:63]
    s_waitcnt lgkmcnt(5)
    v_mfma_f32_16x16x32_bf16 v[148:151], v[20:23], v[184:187], v[148:151]
    ds_read_b128 v[12:15], v7 offset:10240
    v_mfma_f32_16x16x32_bf16 v[152:155], v[20:23], v[188:191], v[152:155]
    v_mfma_f32_16x16x32_bf16 v[156:159], v[20:23], v[192:195], v[156:159]
    s_waitcnt lgkmcnt(5)
    v_mfma_f32_16x16x32_bf16 v[40:43], v[24:27], v[208:211], v[40:43]
    ds_read_b128 v[16:19], v5 offset:0
    v_lshrrev_b32 v1, 5, v0
    v_lshlrev_b32 v1, 10, v1
    v_mfma_f32_16x16x32_bf16 v[44:47], v[24:27], v[212:215], v[44:47]
    v_bfe_u32 v6, v0, 2, 3
    v_lshl_or_b32 v1, v6, 7, v1
    v_mfma_f32_16x16x32_bf16 v[48:51], v[24:27], v[216:219], v[48:51]
    v_bfe_u32 v6, v0, 3, 2
    v_lshl_or_b32 v1, v6, 5, v1
    s_waitcnt lgkmcnt(5)
    v_mfma_f32_16x16x32_bf16 v[76:79], v[28:31], v[208:211], v[76:79]
    ds_read_b128 v[20:23], v5 offset:2048
    v_and_b32 v6, 3, v0
    v_lshl_or_b32 v1, v6, 3, v1
    s_mul_i32 s4, s68, 24576
    s_add_u32 s4, s4, 114688
    v_mfma_f32_16x16x32_bf16 v[80:83], v[28:31], v[212:215], v[80:83]
    v_add_u32 v1, s4, v1
    v_xor_b32 v2, 32, v1
    v_mfma_f32_16x16x32_bf16 v[84:87], v[28:31], v[216:219], v[84:87]
    v_xor_b32 v3, 64, v1
    v_xor_b32 v4, 96, v1
    s_mov_b32 s6, 0x3db8aa3b
    s_lshl_b32 s21, s36, 3
    s_waitcnt lgkmcnt(5)
    v_mfma_f32_16x16x32_bf16 v[100:103], v[32:35], v[208:211], v[100:103]
    ds_read_b128 v[24:27], v5 offset:4096
    v_mfma_f32_16x16x32_bf16 v[104:107], v[32:35], v[212:215], v[104:107]
    v_mfma_f32_16x16x32_bf16 v[108:111], v[32:35], v[216:219], v[108:111]
    s_waitcnt lgkmcnt(5)
    v_mfma_f32_16x16x32_bf16 v[124:127], v[36:39], v[208:211], v[124:127]
    ds_read_b128 v[28:31], v5 offset:6144
    v_mfma_f32_16x16x32_bf16 v[128:131], v[36:39], v[212:215], v[128:131]
    v_mfma_f32_16x16x32_bf16 v[132:135], v[36:39], v[216:219], v[132:135]
    s_waitcnt lgkmcnt(5)
    v_mfma_f32_16x16x32_bf16 v[52:55], v[8:11], v[208:211], v[52:55]
    ds_read_b128 v[32:35], v5 offset:8192
    v_mfma_f32_16x16x32_bf16 v[56:59], v[8:11], v[212:215], v[56:59]
    v_mfma_f32_16x16x32_bf16 v[60:63], v[8:11], v[216:219], v[60:63]
    s_waitcnt lgkmcnt(5)
    v_mfma_f32_16x16x32_bf16 v[148:151], v[12:15], v[208:211], v[148:151]
    ds_read_b128 v[36:39], v5 offset:10240
    v_mfma_f32_16x16x32_bf16 v[152:155], v[12:15], v[212:215], v[152:155]
    v_mfma_f32_16x16x32_bf16 v[156:159], v[12:15], v[216:219], v[156:159]
    s_waitcnt lgkmcnt(5)
    v_mfma_f32_16x16x32_bf16 v[40:43], v[16:19], v[232:235], v[40:43]
    v_mfma_f32_16x16x32_bf16 v[44:47], v[16:19], v[236:239], v[44:47]
    v_mfma_f32_16x16x32_bf16 v[48:51], v[16:19], v[240:243], v[48:51]
    s_waitcnt lgkmcnt(4)
    v_mfma_f32_16x16x32_bf16 v[76:79], v[20:23], v[232:235], v[76:79]
    v_mfma_f32_16x16x32_bf16 v[80:83], v[20:23], v[236:239], v[80:83]
    s_nop 2
    v_max_f32 v172, v40, v41
    v_max_f32 v174, v44, v45
    v_mfma_f32_16x16x32_bf16 v[84:87], v[20:23], v[240:243], v[84:87]
    v_max_f32 v176, v48, v49
    v_max3_f32 v172, v172, v42, v43
    s_waitcnt lgkmcnt(3)
    s_waitcnt lgkmcnt(0)
    s_barrier
    v_mfma_f32_16x16x32_bf16 v[100:103], v[24:27], v[232:235], v[100:103]
    v_max3_f32 v174, v174, v46, v47
    v_max3_f32 v176, v176, v50, v51
    v_mfma_f32_16x16x32_bf16 v[104:107], v[24:27], v[236:239], v[104:107]
    v_max3_f32 v172, v172, v76, v77
    v_max3_f32 v174, v174, v80, v81
    v_mfma_f32_16x16x32_bf16 v[108:111], v[24:27], v[240:243], v[108:111]
    v_max3_f32 v176, v176, v84, v85
    v_max3_f32 v172, v172, v78, v79
    v_mfma_f32_16x16x32_bf16 v[124:127], v[28:31], v[232:235], v[124:127]
    v_max3_f32 v174, v174, v82, v83
    v_max3_f32 v176, v176, v86, v87
    v_mfma_f32_16x16x32_bf16 v[128:131], v[28:31], v[236:239], v[128:131]
    v_max3_f32 v172, v172, v100, v101
    v_max3_f32 v174, v174, v104, v105
    v_mfma_f32_16x16x32_bf16 v[132:135], v[28:31], v[240:243], v[132:135]
    v_max3_f32 v176, v176, v108, v109
    v_max3_f32 v172, v172, v102, v103
    v_mfma_f32_16x16x32_bf16 v[52:55], v[32:35], v[232:235], v[52:55]
    v_max3_f32 v174, v174, v106, v107
    v_max3_f32 v176, v176, v110, v111
    v_mfma_f32_16x16x32_bf16 v[56:59], v[32:35], v[236:239], v[56:59]
    v_max3_f32 v172, v172, v124, v125
    v_max3_f32 v174, v174, v128, v129
    v_mfma_f32_16x16x32_bf16 v[60:63], v[32:35], v[240:243], v[60:63]
    v_max3_f32 v176, v176, v132, v133
    v_max3_f32 v172, v172, v126, v127
    v_mfma_f32_16x16x32_bf16 v[148:151], v[36:39], v[232:235], v[148:151]
    v_max3_f32 v174, v174, v130, v131
    v_max3_f32 v176, v176, v134, v135
    v_mfma_f32_16x16x32_bf16 v[152:155], v[36:39], v[236:239], v[152:155]
    v_max3_f32 v172, v172, v52, v53
    v_max3_f32 v174, v174, v56, v57
    v_mfma_f32_16x16x32_bf16 v[156:159], v[36:39], v[240:243], v[156:159]
    v_max3_f32 v176, v176, v60, v61
    v_max3_f32 v172, v172, v54, v55
    s_load_dwordx2 s[22:23], s[24:25], s21
    v_max3_f32 v174, v174, v58, v59
    v_max3_f32 v176, v176, v62, v63
    v_max3_f32 v172, v172, v148, v149
    v_max3_f32 v174, v174, v152, v153
    s_nop 0
    v_max3_f32 v176, v176, v156, v157
    v_max3_f32 v172, v172, v150, v151
    v_max3_f32 v174, v174, v154, v155
    v_max3_f32 v176, v176, v158, v159
    v_mov_b32 v8, v172
    v_mov_b32 v9, v174
    v_mov_b32 v10, v176
    v_permlane16_swap_b32 v172, v8
    v_permlane16_swap_b32 v174, v9
    v_permlane16_swap_b32 v176, v10
    v_max_f32 v172, v172, v8
    v_max_f32 v174, v174, v9
    v_max_f32 v176, v176, v10
    v_mov_b32 v8, v172
    v_mov_b32 v9, v174
    v_mov_b32 v10, v176
    v_permlane32_swap_b32 v172, v8
    v_permlane32_swap_b32 v174, v9
    v_permlane32_swap_b32 v176, v10
    v_max_f32 v172, v172, v8
    v_max_f32 v174, v174, v9
    v_max_f32 v176, v176, v10
    v_mul_f32 v172, s6, v172
    v_mul_f32 v174, s6, v174
    v_mul_f32 v176, s6, v176
    v_pk_fma_f32 v[40:41], v[40:41], s[6:7], v[172:173] op_sel_hi:[1,0,0] neg_lo:[0,0,1] neg_hi:[0,0,1]
    v_pk_fma_f32 v[44:45], v[44:45], s[6:7], v[174:175] op_sel_hi:[1,0,0] neg_lo:[0,0,1] neg_hi:[0,0,1]
    v_pk_fma_f32 v[48:49], v[48:49], s[6:7], v[176:177] op_sel_hi:[1,0,0] neg_lo:[0,0,1] neg_hi:[0,0,1]
    v_pk_fma_f32 v[42:43], v[42:43], s[6:7], v[172:173] op_sel_hi:[1,0,0] neg_lo:[0,0,1] neg_hi:[0,0,1]
    v_pk_fma_f32 v[46:47], v[46:47], s[6:7], v[174:175] op_sel_hi:[1,0,0] neg_lo:[0,0,1] neg_hi:[0,0,1]
    v_pk_fma_f32 v[50:51], v[50:51], s[6:7], v[176:177] op_sel_hi:[1,0,0] neg_lo:[0,0,1] neg_hi:[0,0,1]
    v_exp_f32 v40, v40
    v_exp_f32 v41, v41
    v_exp_f32 v44, v44
    v_exp_f32 v45, v45
    v_exp_f32 v48, v48
    v_exp_f32 v49, v49
    v_pk_fma_f32 v[76:77], v[76:77], s[6:7], v[172:173] op_sel_hi:[1,0,0] neg_lo:[0,0,1] neg_hi:[0,0,1]
    v_pk_fma_f32 v[80:81], v[80:81], s[6:7], v[174:175] op_sel_hi:[1,0,0] neg_lo:[0,0,1] neg_hi:[0,0,1]
    v_pk_fma_f32 v[84:85], v[84:85], s[6:7], v[176:177] op_sel_hi:[1,0,0] neg_lo:[0,0,1] neg_hi:[0,0,1]
    v_exp_f32 v42, v42
    v_exp_f32 v43, v43
    v_exp_f32 v46, v46
    v_exp_f32 v47, v47
    v_exp_f32 v50, v50
    v_exp_f32 v51, v51
    v_pk_fma_f32 v[78:79], v[78:79], s[6:7], v[172:173] op_sel_hi:[1,0,0] neg_lo:[0,0,1] neg_hi:[0,0,1]
    v_pk_fma_f32 v[82:83], v[82:83], s[6:7], v[174:175] op_sel_hi:[1,0,0] neg_lo:[0,0,1] neg_hi:[0,0,1]
    v_pk_fma_f32 v[86:87], v[86:87], s[6:7], v[176:177] op_sel_hi:[1,0,0] neg_lo:[0,0,1] neg_hi:[0,0,1]
    v_exp_f32 v76, v76
    v_exp_f32 v77, v77
    v_exp_f32 v80, v80
    v_exp_f32 v81, v81
    v_exp_f32 v84, v84
    v_exp_f32 v85, v85
    v_pk_add_f32 v[12:13], v[40:41], v[42:43]
    v_pk_add_f32 v[14:15], v[44:45], v[46:47]
    v_pk_add_f32 v[16:17], v[48:49], v[50:51]
    v_pk_fma_f32 v[100:101], v[100:101], s[6:7], v[172:173] op_sel_hi:[1,0,0] neg_lo:[0,0,1] neg_hi:[0,0,1]
    v_pk_fma_f32 v[104:105], v[104:105], s[6:7], v[174:175] op_sel_hi:[1,0,0] neg_lo:[0,0,1] neg_hi:[0,0,1]
    v_pk_fma_f32 v[108:109], v[108:109], s[6:7], v[176:177] op_sel_hi:[1,0,0] neg_lo:[0,0,1] neg_hi:[0,0,1]
    v_exp_f32 v78, v78
    v_exp_f32 v79, v79
    v_exp_f32 v82, v82
    v_exp_f32 v83, v83
    v_exp_f32 v86, v86
    v_exp_f32 v87, v87
    v_pk_add_f32 v[12:13], v[12:13], v[76:77]
    v_pk_add_f32 v[14:15], v[14:15], v[80:81]
    v_pk_add_f32 v[16:17], v[16:17], v[84:85]
    v_pk_fma_f32 v[102:103], v[102:103], s[6:7], v[172:173] op_sel_hi:[1,0,0] neg_lo:[0,0,1] neg_hi:[0,0,1]
    v_pk_fma_f32 v[106:107], v[106:107], s[6:7], v[174:175] op_sel_hi:[1,0,0] neg_lo:[0,0,1] neg_hi:[0,0,1]
    v_pk_fma_f32 v[110:111], v[110:111], s[6:7], v[176:177] op_sel_hi:[1,0,0] neg_lo:[0,0,1] neg_hi:[0,0,1]
    v_exp_f32 v100, v100
    v_exp_f32 v101, v101
    v_exp_f32 v104, v104
    v_exp_f32 v105, v105
    v_exp_f32 v108, v108
    v_exp_f32 v109, v109
    v_pk_add_f32 v[12:13], v[12:13], v[78:79]
    v_pk_add_f32 v[14:15], v[14:15], v[82:83]
    v_pk_add_f32 v[16:17], v[16:17], v[86:87]
    v_pk_fma_f32 v[124:125], v[124:125], s[6:7], v[172:173] op_sel_hi:[1,0,0] neg_lo:[0,0,1] neg_hi:[0,0,1]
    v_pk_fma_f32 v[128:129], v[128:129], s[6:7], v[174:175] op_sel_hi:[1,0,0] neg_lo:[0,0,1] neg_hi:[0,0,1]
    v_pk_fma_f32 v[132:133], v[132:133], s[6:7], v[176:177] op_sel_hi:[1,0,0] neg_lo:[0,0,1] neg_hi:[0,0,1]
    v_exp_f32 v102, v102
    v_exp_f32 v103, v103
    v_exp_f32 v106, v106
    v_exp_f32 v107, v107
    v_exp_f32 v110, v110
    v_exp_f32 v111, v111
    v_pk_add_f32 v[12:13], v[12:13], v[100:101]
    v_pk_add_f32 v[14:15], v[14:15], v[104:105]
    v_pk_add_f32 v[16:17], v[16:17], v[108:109]
    v_pk_fma_f32 v[126:127], v[126:127], s[6:7], v[172:173] op_sel_hi:[1,0,0] neg_lo:[0,0,1] neg_hi:[0,0,1]
    v_pk_fma_f32 v[130:131], v[130:131], s[6:7], v[174:175] op_sel_hi:[1,0,0] neg_lo:[0,0,1] neg_hi:[0,0,1]
    v_pk_fma_f32 v[134:135], v[134:135], s[6:7], v[176:177] op_sel_hi:[1,0,0] neg_lo:[0,0,1] neg_hi:[0,0,1]
    v_exp_f32 v124, v124
    v_exp_f32 v125, v125
    v_exp_f32 v128, v128
    v_exp_f32 v129, v129
    v_exp_f32 v132, v132
    v_exp_f32 v133, v133
    v_pk_add_f32 v[12:13], v[12:13], v[102:103]
    v_pk_add_f32 v[14:15], v[14:15], v[106:107]
    v_pk_add_f32 v[16:17], v[16:17], v[110:111]
    v_pk_fma_f32 v[52:53], v[52:53], s[6:7], v[172:173] op_sel_hi:[1,0,0] neg_lo:[0,0,1] neg_hi:[0,0,1]
    v_pk_fma_f32 v[56:57], v[56:57], s[6:7], v[174:175] op_sel_hi:[1,0,0] neg_lo:[0,0,1] neg_hi:[0,0,1]
    v_pk_fma_f32 v[60:61], v[60:61], s[6:7], v[176:177] op_sel_hi:[1,0,0] neg_lo:[0,0,1] neg_hi:[0,0,1]
    v_exp_f32 v126, v126
    v_exp_f32 v127, v127
    v_exp_f32 v130, v130
    v_exp_f32 v131, v131
    v_exp_f32 v134, v134
    v_exp_f32 v135, v135
    v_pk_add_f32 v[12:13], v[12:13], v[124:125]
    v_pk_add_f32 v[14:15], v[14:15], v[128:129]
    v_pk_add_f32 v[16:17], v[16:17], v[132:133]
    v_pk_fma_f32 v[54:55], v[54:55], s[6:7], v[172:173] op_sel_hi:[1,0,0] neg_lo:[0,0,1] neg_hi:[0,0,1]
    v_pk_fma_f32 v[58:59], v[58:59], s[6:7], v[174:175] op_sel_hi:[1,0,0] neg_lo:[0,0,1] neg_hi:[0,0,1]
    v_pk_fma_f32 v[62:63], v[62:63], s[6:7], v[176:177] op_sel_hi:[1,0,0] neg_lo:[0,0,1] neg_hi:[0,0,1]
    v_exp_f32 v52, v52
    v_exp_f32 v53, v53
    v_exp_f32 v56, v56
    v_exp_f32 v57, v57
    v_exp_f32 v60, v60
    v_exp_f32 v61, v61
    v_pk_add_f32 v[12:13], v[12:13], v[126:127]
    v_pk_add_f32 v[14:15], v[14:15], v[130:131]
    v_pk_add_f32 v[16:17], v[16:17], v[134:135]
    v_pk_fma_f32 v[148:149], v[148:149], s[6:7], v[172:173] op_sel_hi:[1,0,0] neg_lo:[0,0,1] neg_hi:[0,0,1]
    v_pk_fma_f32 v[152:153], v[152:153], s[6:7], v[174:175] op_sel_hi:[1,0,0] neg_lo:[0,0,1] neg_hi:[0,0,1]
    v_pk_fma_f32 v[156:157], v[156:157], s[6:7], v[176:177] op_sel_hi:[1,0,0] neg_lo:[0,0,1] neg_hi:[0,0,1]
    v_exp_f32 v54, v54
    v_exp_f32 v55, v55
    v_exp_f32 v58, v58
    v_exp_f32 v59, v59
    v_exp_f32 v62, v62
    v_exp_f32 v63, v63
    v_pk_add_f32 v[12:13], v[12:13], v[52:53]
    v_pk_add_f32 v[14:15], v[14:15], v[56:57]
    v_pk_add_f32 v[16:17], v[16:17], v[60:61]
    v_pk_fma_f32 v[150:151], v[150:151], s[6:7], v[172:173] op_sel_hi:[1,0,0] neg_lo:[0,0,1] neg_hi:[0,0,1]
    v_pk_fma_f32 v[154:155], v[154:155], s[6:7], v[174:175] op_sel_hi:[1,0,0] neg_lo:[0,0,1] neg_hi:[0,0,1]
    v_pk_fma_f32 v[158:159], v[158:159], s[6:7], v[176:177] op_sel_hi:[1,0,0] neg_lo:[0,0,1] neg_hi:[0,0,1]
    v_exp_f32 v148, v148
    v_exp_f32 v149, v149
    v_exp_f32 v152, v152
    v_exp_f32 v153, v153
    v_exp_f32 v156, v156
    v_exp_f32 v157, v157
    v_pk_add_f32 v[12:13], v[12:13], v[54:55]
    v_pk_add_f32 v[14:15], v[14:15], v[58:59]
    v_pk_add_f32 v[16:17], v[16:17], v[62:63]
    v_exp_f32 v150, v150
    v_exp_f32 v151, v151
    v_exp_f32 v154, v154
    v_exp_f32 v155, v155
    v_exp_f32 v158, v158
    v_exp_f32 v159, v159
    v_pk_add_f32 v[12:13], v[12:13], v[148:149]
    v_pk_add_f32 v[14:15], v[14:15], v[152:153]
    v_pk_add_f32 v[16:17], v[16:17], v[156:157]
    v_pk_add_f32 v[12:13], v[12:13], v[150:151]
    v_pk_add_f32 v[14:15], v[14:15], v[154:155]
    v_pk_add_f32 v[16:17], v[16:17], v[158:159]
    v_add_f32 v12, v12, v13
    v_add_f32 v14, v14, v15
    v_add_f32 v16, v16, v17
    v_mov_b32 v8, v12
    v_mov_b32 v9, v14
    v_mov_b32 v10, v16
    v_permlane16_swap_b32 v12, v8
    v_permlane16_swap_b32 v14, v9
    v_permlane16_swap_b32 v16, v10
    v_add_f32 v12, v12, v8
    v_add_f32 v14, v14, v9
    v_add_f32 v16, v16, v10
    v_mov_b32 v8, v12
    v_mov_b32 v9, v14
    v_mov_b32 v10, v16
    v_permlane32_swap_b32 v12, v8
    v_permlane32_swap_b32 v14, v9
    v_permlane32_swap_b32 v16, v10
    v_add_f32 v12, v12, v8
    v_add_f32 v14, v14, v9
    v_add_f32 v16, v16, v10
    v_rcp_f32 v12, v12
    v_rcp_f32 v14, v14
    v_rcp_f32 v16, v16
    v_pk_mul_f32 v[40:41], v[40:41], v[12:13] op_sel_hi:[1,0]
    v_pk_mul_f32 v[42:43], v[42:43], v[12:13] op_sel_hi:[1,0]
    v_pk_mul_f32 v[44:45], v[44:45], v[14:15] op_sel_hi:[1,0]
    v_pk_mul_f32 v[46:47], v[46:47], v[14:15] op_sel_hi:[1,0]
    v_pk_mul_f32 v[48:49], v[48:49], v[16:17] op_sel_hi:[1,0]
    v_pk_mul_f32 v[50:51], v[50:51], v[16:17] op_sel_hi:[1,0]
    v_cvt_pk_bf16_f32 v208, v40, v41
    v_cvt_pk_bf16_f32 v209, v42, v43
    v_cvt_pk_bf16_f32 v212, v44, v45
    v_cvt_pk_bf16_f32 v213, v46, v47
    v_cvt_pk_bf16_f32 v216, v48, v49
    v_cvt_pk_bf16_f32 v217, v50, v51
    v_pk_mul_f32 v[76:77], v[76:77], v[12:13] op_sel_hi:[1,0]
    v_pk_mul_f32 v[78:79], v[78:79], v[12:13] op_sel_hi:[1,0]
    v_pk_mul_f32 v[80:81], v[80:81], v[14:15] op_sel_hi:[1,0]
    v_pk_mul_f32 v[82:83], v[82:83], v[14:15] op_sel_hi:[1,0]
    v_pk_mul_f32 v[84:85], v[84:85], v[16:17] op_sel_hi:[1,0]
    v_pk_mul_f32 v[86:87], v[86:87], v[16:17] op_sel_hi:[1,0]
    v_cvt_pk_bf16_f32 v210, v76, v77
    v_cvt_pk_bf16_f32 v211, v78, v79
    v_cvt_pk_bf16_f32 v214, v80, v81
    v_cvt_pk_bf16_f32 v215, v82, v83
    v_cvt_pk_bf16_f32 v218, v84, v85
    v_cvt_pk_bf16_f32 v219, v86, v87
    v_pk_mul_f32 v[100:101], v[100:101], v[12:13] op_sel_hi:[1,0]
    v_pk_mul_f32 v[102:103], v[102:103], v[12:13] op_sel_hi:[1,0]
    v_pk_mul_f32 v[104:105], v[104:105], v[14:15] op_sel_hi:[1,0]
    v_pk_mul_f32 v[106:107], v[106:107], v[14:15] op_sel_hi:[1,0]
    v_pk_mul_f32 v[108:109], v[108:109], v[16:17] op_sel_hi:[1,0]
    v_pk_mul_f32 v[110:111], v[110:111], v[16:17] op_sel_hi:[1,0]
    v_cvt_pk_bf16_f32 v220, v100, v101
    v_cvt_pk_bf16_f32 v221, v102, v103
    v_cvt_pk_bf16_f32 v224, v104, v105
    v_cvt_pk_bf16_f32 v225, v106, v107
    v_cvt_pk_bf16_f32 v228, v108, v109
    v_cvt_pk_bf16_f32 v229, v110, v111
    v_pk_mul_f32 v[124:125], v[124:125], v[12:13] op_sel_hi:[1,0]
    v_pk_mul_f32 v[126:127], v[126:127], v[12:13] op_sel_hi:[1,0]
    v_pk_mul_f32 v[128:129], v[128:129], v[14:15] op_sel_hi:[1,0]
    v_pk_mul_f32 v[130:131], v[130:131], v[14:15] op_sel_hi:[1,0]
    v_pk_mul_f32 v[132:133], v[132:133], v[16:17] op_sel_hi:[1,0]
    v_pk_mul_f32 v[134:135], v[134:135], v[16:17] op_sel_hi:[1,0]
    v_cvt_pk_bf16_f32 v222, v124, v125
    v_cvt_pk_bf16_f32 v223, v126, v127
    v_cvt_pk_bf16_f32 v226, v128, v129
    v_cvt_pk_bf16_f32 v227, v130, v131
    v_cvt_pk_bf16_f32 v230, v132, v133
    v_cvt_pk_bf16_f32 v231, v134, v135
    v_pk_mul_f32 v[52:53], v[52:53], v[12:13] op_sel_hi:[1,0]
    v_pk_mul_f32 v[54:55], v[54:55], v[12:13] op_sel_hi:[1,0]
    v_pk_mul_f32 v[56:57], v[56:57], v[14:15] op_sel_hi:[1,0]
    v_pk_mul_f32 v[58:59], v[58:59], v[14:15] op_sel_hi:[1,0]
    v_pk_mul_f32 v[60:61], v[60:61], v[16:17] op_sel_hi:[1,0]
    v_pk_mul_f32 v[62:63], v[62:63], v[16:17] op_sel_hi:[1,0]
    v_cvt_pk_bf16_f32 v232, v52, v53
    v_cvt_pk_bf16_f32 v233, v54, v55
    v_cvt_pk_bf16_f32 v236, v56, v57
    v_cvt_pk_bf16_f32 v237, v58, v59
    v_cvt_pk_bf16_f32 v240, v60, v61
    v_cvt_pk_bf16_f32 v241, v62, v63
    v_pk_mul_f32 v[148:149], v[148:149], v[12:13] op_sel_hi:[1,0]
    v_pk_mul_f32 v[150:151], v[150:151], v[12:13] op_sel_hi:[1,0]
    v_pk_mul_f32 v[152:153], v[152:153], v[14:15] op_sel_hi:[1,0]
    v_pk_mul_f32 v[154:155], v[154:155], v[14:15] op_sel_hi:[1,0]
    v_pk_mul_f32 v[156:157], v[156:157], v[16:17] op_sel_hi:[1,0]
    v_pk_mul_f32 v[158:159], v[158:159], v[16:17] op_sel_hi:[1,0]
    v_cvt_pk_bf16_f32 v234, v148, v149
    v_cvt_pk_bf16_f32 v235, v150, v151
    v_cvt_pk_bf16_f32 v238, v152, v153
    v_cvt_pk_bf16_f32 v239, v154, v155
    v_cvt_pk_bf16_f32 v242, v156, v157
    v_cvt_pk_bf16_f32 v243, v158, v159
    s_waitcnt lgkmcnt(0)
    s_cmp_eq_u32 s23, 0
    s_cbranch_scc1 L_cns
L_cnb:
    s_barrier
    ds_read_b64_tr_b16 v[8:9], v1 offset:0
    ds_read_b64_tr_b16 v[10:11], v1 offset:2048
    ds_read_b64_tr_b16 v[12:13], v1 offset:4096
    ds_read_b64_tr_b16 v[14:15], v1 offset:6144
    ds_read_b64_tr_b16 v[16:17], v1 offset:8192
    ds_read_b64_tr_b16 v[18:19], v1 offset:10240
    ds_read_b64_tr_b16 v[20:21], v2 offset:0
    ds_read_b64_tr_b16 v[22:23], v2 offset:2048
    ds_read_b64_tr_b16 v[24:25], v2 offset:4096
    ds_read_b64_tr_b16 v[26:27], v2 offset:6144
    s_waitcnt lgkmcnt(6)
    v_mfma_f32_16x16x32_bf16 v[136:139], v[8:11], v[208:211], 0
    ds_read_b64_tr_b16 v[28:29], v2 offset:8192
    v_subrev_u32 v248, 49152, v1
    v_mfma_f32_16x16x32_bf16 v[140:143], v[8:11], v[212:215], 0
    ds_read_b64_tr_b16 v[30:31], v2 offset:10240
    v_subrev_u32 v249, 49152, v2
    v_mfma_f32_16x16x32_bf16 v[144:147], v[8:11], v[216:219], 0
    v_subrev_u32 v250, 49152, v3
    v_subrev_u32 v251, 49152, v4
    v_mfma_f32_16x16x32_bf16 v[136:139], v[12:15], v[220:223], v[136:139]
    ds_read_b64_tr_b16 v[32:33], v3 offset:0
    s_lshl_b32 s5, s68, 6
    v_mfma_f32_16x16x32_bf16 v[140:143], v[12:15], v[224:227], v[140:143]
    ds_read_b64_tr_b16 v[34:35], v3 offset:2048
    v_xor_b32 v244, s5, v1
    v_mfma_f32_16x16x32_bf16 v[144:147], v[12:15], v[228:231], v[144:147]
    s_mul_i32 s4, s68, -16384
    s_waitcnt lgkmcnt(6)
    v_mfma_f32_16x16x32_bf16 v[136:139], v[16:19], v[232:235], v[136:139]
    ds_read_b64_tr_b16 v[36:37], v3 offset:4096
    s_add_u32 s4, s4, -114688
    v_mfma_f32_16x16x32_bf16 v[140:143], v[16:19], v[236:239], v[140:143]
    ds_read_b64_tr_b16 v[38:39], v3 offset:6144
    v_add_u32 v244, s4, v244
    v_mfma_f32_16x16x32_bf16 v[144:147], v[16:19], v[240:243], v[144:147]
    v_xor_b32 v245, 32, v244
    v_xor_b32 v246, 64, v244
    v_mfma_f32_16x16x32_bf16 v[148:151], v[20:23], v[208:211], 0
    ds_read_b64_tr_b16 v[8:9], v3 offset:8192
    v_xor_b32 v247, 96, v244
    v_mfma_f32_16x16x32_bf16 v[152:155], v[20:23], v[212:215], 0
    ds_read_b64_tr_b16 v[10:11], v3 offset:10240
    v_mfma_f32_16x16x32_bf16 v[156:159], v[20:23], v[216:219], 0
    s_waitcnt lgkmcnt(6)
    v_mfma_f32_16x16x32_bf16 v[148:151], v[24:27], v[220:223], v[148:151]
    ds_read_b64_tr_b16 v[12:13], v4 offset:0
    v_cvt_pk_bf16_f32 v40, v136, v137
    v_mfma_f32_16x16x32_bf16 v[152:155], v[24:27], v[224:227], v[152:155]
    ds_read_b64_tr_b16 v[14:15], v4 offset:2048
    v_cvt_pk_bf16_f32 v41, v138, v139
    v_mfma_f32_16x16x32_bf16 v[156:159], v[24:27], v[228:231], v[156:159]
    v_cvt_pk_bf16_f32 v44, v140, v141
    v_cvt_pk_bf16_f32 v45, v142, v143
    v_mfma_f32_16x16x32_bf16 v[148:151], v[28:31], v[232:235], v[148:151]
    ds_read_b64_tr_b16 v[16:17], v4 offset:4096
    v_cvt_pk_bf16_f32 v48, v144, v145
    v_mfma_f32_16x16x32_bf16 v[152:155], v[28:31], v[236:239], v[152:155]
    ds_read_b64_tr_b16 v[18:19], v4 offset:6144
    v_cvt_pk_bf16_f32 v49, v146, v147
    v_mfma_f32_16x16x32_bf16 v[156:159], v[28:31], v[240:243], v[156:159]
    s_waitcnt lgkmcnt(6)
    v_mfma_f32_16x16x32_bf16 v[160:163], v[32:35], v[208:211], 0
    ds_read_b64_tr_b16 v[20:21], v4 offset:8192
    v_mfma_f32_16x16x32_bf16 v[164:167], v[32:35], v[212:215], 0
    ds_read_b64_tr_b16 v[22:23], v4 offset:10240
    v_mfma_f32_16x16x32_bf16 v[168:171], v[32:35], v[216:219], 0
    v_mfma_f32_16x16x32_bf16 v[160:163], v[36:39], v[220:223], v[160:163]
    ds_read_b64_tr_b16 v[24:25], v1 offset:12288
    v_cvt_pk_bf16_f32 v42, v148, v149
    v_mfma_f32_16x16x32_bf16 v[164:167], v[36:39], v[224:227], v[164:167]
    ds_read_b64_tr_b16 v[26:27], v1 offset:14336
    v_cvt_pk_bf16_f32 v43, v150, v151
    v_mfma_f32_16x16x32_bf16 v[168:171], v[36:39], v[228:231], v[168:171]
    v_cvt_pk_bf16_f32 v46, v152, v153
    s_waitcnt lgkmcnt(6)
    v_mfma_f32_16x16x32_bf16 v[160:163], v[8:11], v[232:235], v[160:163]
    ds_read_b64_tr_b16 v[28:29], v1 offset:16384
    v_cvt_pk_bf16_f32 v47, v154, v155
    v_mfma_f32_16x16x32_bf16 v[164:167], v[8:11], v[236:239], v[164:167]
    ds_read_b64_tr_b16 v[30:31], v1 offset:18432
    v_cvt_pk_bf16_f32 v50, v156, v157
    v_mfma_f32_16x16x32_bf16 v[168:171], v[8:11], v[240:243], v[168:171]
    v_cvt_pk_bf16_f32 v51, v158, v159
    v_mfma_f32_16x16x32_bf16 v[172:175], v[12:15], v[208:211], 0
    ds_read_b64_tr_b16 v[32:33], v1 offset:20480
    v_mfma_f32_16x16x32_bf16 v[176:179], v[12:15], v[212:215], 0
    ds_read_b64_tr_b16 v[34:35], v1 offset:22528
    v_mfma_f32_16x16x32_bf16 v[180:183], v[12:15], v[216:219], 0
    s_waitcnt lgkmcnt(6)
    v_mfma_f32_16x16x32_bf16 v[172:175], v[16:19], v[220:223], v[172:175]
    ds_read_b64_tr_b16 v[36:37], v2 offset:12288
    v_cvt_pk_bf16_f32 v52, v160, v161
    v_mfma_f32_16x16x32_bf16 v[176:179], v[16:19], v[224:227], v[176:179]
    ds_read_b64_tr_b16 v[38:39], v2 offset:14336
    v_cvt_pk_bf16_f32 v53, v162, v163
    v_mfma_f32_16x16x32_bf16 v[180:183], v[16:19], v[228:231], v[180:183]
    v_cvt_pk_bf16_f32 v56, v164, v165
    v_cvt_pk_bf16_f32 v57, v166, v167
    v_mfma_f32_16x16x32_bf16 v[172:175], v[20:23], v[232:235], v[172:175]
    ds_read_b64_tr_b16 v[8:9], v2 offset:16384
    v_cvt_pk_bf16_f32 v60, v168, v169
    v_mfma_f32_16x16x32_bf16 v[176:179], v[20:23], v[236:239], v[176:179]
    ds_read_b64_tr_b16 v[10:11], v2 offset:18432
    v_cvt_pk_bf16_f32 v61, v170, v171
    v_mfma_f32_16x16x32_bf16 v[180:183], v[20:23], v[240:243], v[180:183]
    s_waitcnt lgkmcnt(6)
    v_mfma_f32_16x16x32_bf16 v[184:187], v[24:27], v[208:211], 0
    ds_read_b64_tr_b16 v[12:13], v2 offset:20480
    v_mfma_f32_16x16x32_bf16 v[188:191], v[24:27], v[212:215], 0
    ds_read_b64_tr_b16 v[14:15], v2 offset:22528
    v_mfma_f32_16x16x32_bf16 v[192:195], v[24:27], v[216:219], 0
    v_mfma_f32_16x16x32_bf16 v[184:187], v[28:31], v[220:223], v[184:187]
    ds_read_b64_tr_b16 v[16:17], v3 offset:12288
    v_cvt_pk_bf16_f32 v54, v172, v173
    v_mfma_f32_16x16x32_bf16 v[188:191], v[28:31], v[224:227], v[188:191]
    ds_read_b64_tr_b16 v[18:19], v3 offset:14336
    v_cvt_pk_bf16_f32 v55, v174, v175
    v_mfma_f32_16x16x32_bf16 v[192:195], v[28:31], v[228:231], v[192:195]
    v_cvt_pk_bf16_f32 v58, v176, v177
    s_waitcnt lgkmcnt(6)
    v_mfma_f32_16x16x32_bf16 v[184:187], v[32:35], v[232:235], v[184:187]
    ds_read_b64_tr_b16 v[20:21], v3 offset:16384
    v_cvt_pk_bf16_f32 v59, v178, v179
    v_mfma_f32_16x16x32_bf16 v[188:191], v[32:35], v[236:239], v[188:191]
    ds_read_b64_tr_b16 v[22:23], v3 offset:18432
    v_cvt_pk_bf16_f32 v62, v180, v181
    v_mfma_f32_16x16x32_bf16 v[192:195], v[32:35], v[240:243], v[192:195]
    v_cvt_pk_bf16_f32 v63, v182, v183
    v_mfma_f32_16x16x32_bf16 v[196:199], v[36:39], v[208:211], 0
    ds_read_b64_tr_b16 v[24:25], v3 offset:20480
    v_mfma_f32_16x16x32_bf16 v[200:203], v[36:39], v[212:215], 0
    ds_read_b64_tr_b16 v[26:27], v3 offset:22528
    v_mfma_f32_16x16x32_bf16 v[204:207], v[36:39], v[216:219], 0
    s_waitcnt lgkmcnt(6)
    v_mfma_f32_16x16x32_bf16 v[196:199], v[8:11], v[220:223], v[196:199]
    ds_read_b64_tr_b16 v[28:29], v4 offset:12288
    v_cvt_pk_bf16_f32 v64, v184, v185
    v_mfma_f32_16x16x32_bf16 v[200:203], v[8:11], v[224:227], v[200:203]
    ds_read_b64_tr_b16 v[30:31], v4 offset:14336
    v_cvt_pk_bf16_f32 v65, v186, v187
    v_mfma_f32_16x16x32_bf16 v[204:207], v[8:11], v[228:231], v[204:207]
    v_cvt_pk_bf16_f32 v68, v188, v189
    v_cvt_pk_bf16_f32 v69, v190, v191
    v_mfma_f32_16x16x32_bf16 v[196:199], v[12:15], v[232:235], v[196:199]
    ds_read_b64_tr_b16 v[32:33], v4 offset:16384
    v_cvt_pk_bf16_f32 v72, v192, v193
    v_mfma_f32_16x16x32_bf16 v[200:203], v[12:15], v[236:239], v[200:203]
    ds_read_b64_tr_b16 v[34:35], v4 offset:18432
    v_cvt_pk_bf16_f32 v73, v194, v195
    v_mfma_f32_16x16x32_bf16 v[204:207], v[12:15], v[240:243], v[204:207]
    s_waitcnt lgkmcnt(6)
    v_mfma_f32_16x16x32_bf16 v[136:139], v[16:19], v[208:211], 0
    ds_read_b64_tr_b16 v[36:37], v4 offset:20480
    v_mfma_f32_16x16x32_bf16 v[140:143], v[16:19], v[212:215], 0
    ds_read_b64_tr_b16 v[38:39], v4 offset:22528
    v_mfma_f32_16x16x32_bf16 v[144:147], v[16:19], v[216:219], 0
    v_mfma_f32_16x16x32_bf16 v[136:139], v[20:23], v[220:223], v[136:139]
    s_barrier
    ds_read_b64_tr_b16 v[8:9], v248 offset:0
    v_cvt_pk_bf16_f32 v66, v196, v197
    v_mfma_f32_16x16x32_bf16 v[140:143], v[20:23], v[224:227], v[140:143]
    ds_read_b64_tr_b16 v[10:11], v248 offset:2048
    v_cvt_pk_bf16_f32 v67, v198, v199
    v_mfma_f32_16x16x32_bf16 v[144:147], v[20:23], v[228:231], v[144:147]
    v_cvt_pk_bf16_f32 v70, v200, v201
    s_waitcnt lgkmcnt(6)
    v_mfma_f32_16x16x32_bf16 v[136:139], v[24:27], v[232:235], v[136:139]
    ds_read_b64_tr_b16 v[12:13], v248 offset:8192
    v_cvt_pk_bf16_f32 v71, v202, v203
    v_mfma_f32_16x16x32_bf16 v[140:143], v[24:27], v[236:239], v[140:143]
    ds_read_b64_tr_b16 v[14:15], v248 offset:10240
    v_cvt_pk_bf16_f32 v74, v204, v205
    v_mfma_f32_16x16x32_bf16 v[144:147], v[24:27], v[240:243], v[144:147]
    v_cvt_pk_bf16_f32 v75, v206, v207
    v_mfma_f32_16x16x32_bf16 v[148:151], v[28:31], v[208:211], 0
    ds_read_b64_tr_b16 v[16:17], v249 offset:0
    v_mfma_f32_16x16x32_bf16 v[152:155], v[28:31], v[212:215], 0
    ds_read_b64_tr_b16 v[18:19], v249 offset:2048
    v_mfma_f32_16x16x32_bf16 v[156:159], v[28:31], v[216:219], 0
    s_waitcnt lgkmcnt(6)
    v_mfma_f32_16x16x32_bf16 v[148:151], v[32:35], v[220:223], v[148:151]
    ds_read_b64_tr_b16 v[20:21], v249 offset:8192
    v_cvt_pk_bf16_f32 v76, v136, v137
    v_mfma_f32_16x16x32_bf16 v[152:155], v[32:35], v[224:227], v[152:155]
    ds_read_b64_tr_b16 v[22:23], v249 offset:10240
    v_cvt_pk_bf16_f32 v77, v138, v139
    v_mfma_f32_16x16x32_bf16 v[156:159], v[32:35], v[228:231], v[156:159]
    v_cvt_pk_bf16_f32 v80, v140, v141
    v_cvt_pk_bf16_f32 v81, v142, v143
    v_mfma_f32_16x16x32_bf16 v[148:151], v[36:39], v[232:235], v[148:151]
    ds_read_b64_tr_b16 v[24:25], v250 offset:0
    v_cvt_pk_bf16_f32 v84, v144, v145
    v_mfma_f32_16x16x32_bf16 v[152:155], v[36:39], v[236:239], v[152:155]
    ds_read_b64_tr_b16 v[26:27], v250 offset:2048
    v_cvt_pk_bf16_f32 v85, v146, v147
    v_mfma_f32_16x16x32_bf16 v[156:159], v[36:39], v[240:243], v[156:159]
    s_waitcnt lgkmcnt(6)
    v_mfma_f32_16x16x32_bf16 v[112:115], v[8:11], v[208:211], 0
    ds_read_b64_tr_b16 v[28:29], v250 offset:8192
    v_mfma_f32_16x16x32_bf16 v[116:119], v[8:11], v[212:215], 0
    ds_read_b64_tr_b16 v[30:31], v250 offset:10240
    v_mfma_f32_16x16x32_bf16 v[120:123], v[8:11], v[216:219], 0
    v_mfma_f32_16x16x32_bf16 v[112:115], v[12:15], v[232:235], v[112:115]
    ds_read_b64_tr_b16 v[32:33], v251 offset:0
    v_cvt_pk_bf16_f32 v78, v148, v149
    v_mfma_f32_16x16x32_bf16 v[116:119], v[12:15], v[236:239], v[116:119]
    ds_read_b64_tr_b16 v[34:35], v251 offset:2048
    v_cvt_pk_bf16_f32 v79, v150, v151
    v_mfma_f32_16x16x32_bf16 v[120:123], v[12:15], v[240:243], v[120:123]
    v_cvt_pk_bf16_f32 v82, v152, v153
    s_waitcnt lgkmcnt(6)
    v_mfma_f32_16x16x32_bf16 v[124:127], v[16:19], v[208:211], 0
    ds_read_b64_tr_b16 v[36:37], v251 offset:8192
    v_cvt_pk_bf16_f32 v83, v154, v155
    v_mfma_f32_16x16x32_bf16 v[128:131], v[16:19], v[212:215], 0
    ds_read_b64_tr_b16 v[38:39], v251 offset:10240
    v_cvt_pk_bf16_f32 v86, v156, v157
    v_mfma_f32_16x16x32_bf16 v[132:135], v[16:19], v[216:219], 0
    v_cvt_pk_bf16_f32 v87, v158, v159
    v_add_u32 v1, 98304, v244
    v_mfma_f32_16x16x32_bf16 v[124:127], v[20:23], v[232:235], v[124:127]
    ds_read_b64_tr_b16 v[8:9], v248 offset:12288
    v_add_u32 v2, 98304, v245
    v_mfma_f32_16x16x32_bf16 v[128:131], v[20:23], v[236:239], v[128:131]
    ds_read_b64_tr_b16 v[10:11], v248 offset:14336
    v_add_u32 v3, 98304, v246
    v_mfma_f32_16x16x32_bf16 v[132:135], v[20:23], v[240:243], v[132:135]
    v_add_u32 v4, 98304, v247
    s_waitcnt lgkmcnt(6)
    v_mfma_f32_16x16x32_bf16 v[184:187], v[24:27], v[208:211], 0
    ds_read_b64_tr_b16 v[12:13], v248 offset:20480
    s_xor_b32 s11, s3, 2
    v_mfma_f32_16x16x32_bf16 v[188:191], v[24:27], v[212:215], 0
    ds_read_b64_tr_b16 v[14:15], v248 offset:22528
    s_mul_i32 s4, s3, 6400
    v_mfma_f32_16x16x32_bf16 v[192:195], v[24:27], v[216:219], 0
    s_add_u32 m0, s4, 40960
    s_mul_i32 s4, s11, 6400
    v_mfma_f32_16x16x32_bf16 v[184:187], v[28:31], v[232:235], v[184:187]
    ds_read_b64_tr_b16 v[16:17], v249 offset:12288
    s_add_u32 s4, s4, 65536
    v_mfma_f32_16x16x32_bf16 v[188:191], v[28:31], v[236:239], v[188:191]
    ds_read_b64_tr_b16 v[18:19], v249 offset:14336
    v_lshl_add_u32 v252, v0, 2, s4
    v_mfma_f32_16x16x32_bf16 v[192:195], v[28:31], v[240:243], v[192:195]
    s_mov_b32 s12, 0x07060302
    s_waitcnt lgkmcnt(6)
    v_mfma_f32_16x16x32_bf16 v[196:199], v[32:35], v[208:211], 0
    ds_read_b64_tr_b16 v[20:21], v249 offset:20480
    s_mov_b32 s13, 0x8000
    v_mfma_f32_16x16x32_bf16 v[200:203], v[32:35], v[212:215], 0
    ds_read_b64_tr_b16 v[22:23], v249 offset:22528
    v_lshlrev_b32 v254, 4, v0
    v_mfma_f32_16x16x32_bf16 v[204:207], v[32:35], v[216:219], 0
    s_mul_i32 s4, s3, 6144
    s_add_u32 s4, s4, 131072
    v_mfma_f32_16x16x32_bf16 v[196:199], v[36:39], v[232:235], v[196:199]
    ds_read_b64_tr_b16 v[24:25], v250 offset:12288
    v_add_u32 v253, s4, v254
    v_mfma_f32_16x16x32_bf16 v[200:203], v[36:39], v[236:239], v[200:203]
    ds_read_b64_tr_b16 v[26:27], v250 offset:14336
    s_mov_b32 s15, 0x10001
    v_mfma_f32_16x16x32_bf16 v[204:207], v[36:39], v[240:243], v[204:207]
    s_lshl_b32 s8, s36, 3
    s_waitcnt lgkmcnt(6)
    v_mfma_f32_16x16x32_bf16 v[160:163], v[8:11], v[208:211], 0
    ds_read_b64_tr_b16 v[28:29], v250 offset:20480
    s_add_u32 s8, s8, s39
    v_mfma_f32_16x16x32_bf16 v[164:167], v[8:11], v[212:215], 0
    ds_read_b64_tr_b16 v[30:31], v250 offset:22528
    s_mul_i32 s10, s8, 114688
    v_mfma_f32_16x16x32_bf16 v[168:171], v[8:11], v[216:219], 0
    s_add_u32 s10, s10, 0
    s_lshl_b32 s4, s3, 12
    v_mfma_f32_16x16x32_bf16 v[160:163], v[12:15], v[232:235], v[160:163]
    ds_read_b64_tr_b16 v[32:33], v251 offset:12288
    s_add_u32 s10, s10, s4
    v_mfma_f32_16x16x32_bf16 v[164:167], v[12:15], v[236:239], v[164:167]
    ds_read_b64_tr_b16 v[34:35], v251 offset:14336
    s_mov_b32 s6, 0
    v_mfma_f32_16x16x32_bf16 v[168:171], v[12:15], v[240:243], v[168:171]
    s_waitcnt lgkmcnt(6)
    v_mfma_f32_16x16x32_bf16 v[172:175], v[16:19], v[208:211], 0
    ds_read_b64_tr_b16 v[36:37], v251 offset:20480
    v_mfma_f32_16x16x32_bf16 v[176:179], v[16:19], v[212:215], 0
    ds_read_b64_tr_b16 v[38:39], v251 offset:22528
    v_mfma_f32_16x16x32_bf16 v[180:183], v[16:19], v[216:219], 0
    v_mfma_f32_16x16x32_bf16 v[172:175], v[20:23], v[232:235], v[172:175]
    s_barrier
    ds_read_b64_tr_b16 v[8:9], v250 offset:4096
    v_mfma_f32_16x16x32_bf16 v[176:179], v[20:23], v[236:239], v[176:179]
    ds_read_b64_tr_b16 v[10:11], v250 offset:6144
    v_mfma_f32_16x16x32_bf16 v[180:183], v[20:23], v[240:243], v[180:183]
    s_waitcnt lgkmcnt(6)
    v_mfma_f32_16x16x32_bf16 v[136:139], v[24:27], v[208:211], 0
    ds_read_b64_tr_b16 v[12:13], v251 offset:4096
    v_mfma_f32_16x16x32_bf16 v[140:143], v[24:27], v[212:215], 0
    ds_read_b64_tr_b16 v[14:15], v251 offset:6144
    v_mfma_f32_16x16x32_bf16 v[144:147], v[24:27], v[216:219], 0
    v_mfma_f32_16x16x32_bf16 v[136:139], v[28:31], v[232:235], v[136:139]
    ds_read_b64_tr_b16 v[16:17], v248 offset:4096
    v_mfma_f32_16x16x32_bf16 v[140:143], v[28:31], v[236:239], v[140:143]
    ds_read_b64_tr_b16 v[18:19], v248 offset:6144
    v_mfma_f32_16x16x32_bf16 v[144:147], v[28:31], v[240:243], v[144:147]
    s_waitcnt lgkmcnt(6)
    v_mfma_f32_16x16x32_bf16 v[148:151], v[32:35], v[208:211], 0
    ds_read_b64_tr_b16 v[20:21], v249 offset:4096
    v_mfma_f32_16x16x32_bf16 v[152:155], v[32:35], v[212:215], 0
    ds_read_b64_tr_b16 v[22:23], v249 offset:6144
    v_mfma_f32_16x16x32_bf16 v[156:159], v[32:35], v[216:219], 0
    v_mfma_f32_16x16x32_bf16 v[148:151], v[36:39], v[232:235], v[148:151]
    ds_read_b64_tr_b16 v[24:25], v248 offset:16384
    v_mfma_f32_16x16x32_bf16 v[152:155], v[36:39], v[236:239], v[152:155]
    ds_read_b64_tr_b16 v[26:27], v248 offset:18432
    v_mfma_f32_16x16x32_bf16 v[156:159], v[36:39], v[240:243], v[156:159]
    s_waitcnt lgkmcnt(6)
    v_mfma_f32_16x16x32_bf16 v[184:187], v[8:11], v[220:223], v[184:187]
    ds_read_b64_tr_b16 v[28:29], v249 offset:16384
    v_mfma_f32_16x16x32_bf16 v[188:191], v[8:11], v[224:227], v[188:191]
    ds_read_b64_tr_b16 v[30:31], v249 offset:18432
    v_mfma_f32_16x16x32_bf16 v[192:195], v[8:11], v[228:231], v[192:195]
    v_mfma_f32_16x16x32_bf16 v[196:199], v[12:15], v[220:223], v[196:199]
    ds_read_b64_tr_b16 v[32:33], v250 offset:16384
    v_mfma_f32_16x16x32_bf16 v[200:203], v[12:15], v[224:227], v[200:203]
    ds_read_b64_tr_b16 v[34:35], v250 offset:18432
    v_mfma_f32_16x16x32_bf16 v[204:207], v[12:15], v[228:231], v[204:207]
    s_waitcnt lgkmcnt(6)
    v_mfma_f32_16x16x32_bf16 v[112:115], v[16:19], v[220:223], v[112:115]
    ds_read_b64_tr_b16 v[36:37], v251 offset:16384
    v_cvt_pk_bf16_f32 v100, v184, v185
    v_mfma_f32_16x16x32_bf16 v[116:119], v[16:19], v[224:227], v[116:119]
    ds_read_b64_tr_b16 v[38:39], v251 offset:18432
    v_cvt_pk_bf16_f32 v101, v186, v187
    v_mfma_f32_16x16x32_bf16 v[120:123], v[16:19], v[228:231], v[120:123]
    v_cvt_pk_bf16_f32 v104, v188, v189
    v_cvt_pk_bf16_f32 v105, v190, v191
    v_mfma_f32_16x16x32_bf16 v[124:127], v[20:23], v[220:223], v[124:127]
    v_cvt_pk_bf16_f32 v108, v192, v193
    v_cvt_pk_bf16_f32 v109, v194, v195
    v_mfma_f32_16x16x32_bf16 v[128:131], v[20:23], v[224:227], v[128:131]
    v_cvt_pk_bf16_f32 v102, v196, v197
    v_cvt_pk_bf16_f32 v103, v198, v199
    v_mfma_f32_16x16x32_bf16 v[132:135], v[20:23], v[228:231], v[132:135]
    v_cvt_pk_bf16_f32 v106, v200, v201
    s_waitcnt lgkmcnt(4)
    v_mfma_f32_16x16x32_bf16 v[160:163], v[24:27], v[220:223], v[160:163]
    v_cvt_pk_bf16_f32 v107, v202, v203
    v_cvt_pk_bf16_f32 v110, v204, v205
    v_mfma_f32_16x16x32_bf16 v[164:167], v[24:27], v[224:227], v[164:167]
    v_cvt_pk_bf16_f32 v111, v206, v207
    v_cvt_pk_bf16_f32 v88, v112, v113
    v_mfma_f32_16x16x32_bf16 v[168:171], v[24:27], v[228:231], v[168:171]
    v_cvt_pk_bf16_f32 v89, v114, v115
    v_cvt_pk_bf16_f32 v92, v116, v117
    v_mfma_f32_16x16x32_bf16 v[172:175], v[28:31], v[220:223], v[172:175]
    v_cvt_pk_bf16_f32 v93, v118, v119
    v_cvt_pk_bf16_f32 v96, v120, v121
    v_mfma_f32_16x16x32_bf16 v[176:179], v[28:31], v[224:227], v[176:179]
    v_cvt_pk_bf16_f32 v97, v122, v123
    v_cvt_pk_bf16_f32 v90, v124, v125
    v_mfma_f32_16x16x32_bf16 v[180:183], v[28:31], v[228:231], v[180:183]
    v_cvt_pk_bf16_f32 v91, v126, v127
    s_waitcnt lgkmcnt(0)
    v_mfma_f32_16x16x32_bf16 v[136:139], v[32:35], v[220:223], v[136:139]
    v_cvt_pk_bf16_f32 v94, v128, v129
    v_cvt_pk_bf16_f32 v95, v130, v131
    v_mfma_f32_16x16x32_bf16 v[140:143], v[32:35], v[224:227], v[140:143]
    v_cvt_pk_bf16_f32 v98, v132, v133
    v_cvt_pk_bf16_f32 v99, v134, v135
    v_mfma_f32_16x16x32_bf16 v[144:147], v[32:35], v[228:231], v[144:147]
    v_cvt_pk_bf16_f32 v112, v160, v161
    v_cvt_pk_bf16_f32 v113, v162, v163
    v_mfma_f32_16x16x32_bf16 v[148:151], v[36:39], v[220:223], v[148:151]
    v_cvt_pk_bf16_f32 v116, v164, v165
    v_cvt_pk_bf16_f32 v117, v166, v167
    v_mfma_f32_16x16x32_bf16 v[152:155], v[36:39], v[224:227], v[152:155]
    v_cvt_pk_bf16_f32 v120, v168, v169
    v_cvt_pk_bf16_f32 v121, v170, v171
    v_mfma_f32_16x16x32_bf16 v[156:159], v[36:39], v[228:231], v[156:159]
    v_cvt_pk_bf16_f32 v114, v172, v173
    v_cvt_pk_bf16_f32 v115, v174, v175
    v_cvt_pk_bf16_f32 v118, v176, v177
    v_cvt_pk_bf16_f32 v119, v178, v179
    v_cvt_pk_bf16_f32 v122, v180, v181
    v_cvt_pk_bf16_f32 v123, v182, v183
    v_cvt_pk_bf16_f32 v124, v136, v137
    v_cvt_pk_bf16_f32 v125, v138, v139
    v_cvt_pk_bf16_f32 v128, v140, v141
    v_cvt_pk_bf16_f32 v129, v142, v143
    v_cvt_pk_bf16_f32 v132, v144, v145
    v_cvt_pk_bf16_f32 v133, v146, v147
    s_mul_i32 s22, s22, 0x9e3779b1
    s_lshr_b32 s4, s22, 15
    s_xor_b32 s22, s22, s4
    v_and_b32 v232, 3, v0
    v_lshlrev_b32 v232, 3, v232
    v_lshrrev_b32 v232, v232, s22
    v_and_b32 v232, 0xff, v232
    v_lshl_or_b32 v232, v232, 15, v232
    v_lshrrev_b32 v248, 0, v232
    v_lshrrev_b32 v249, 2, v232
    v_lshrrev_b32 v250, 4, v232
    v_lshrrev_b32 v251, 6, v232
    v_cvt_pk_bf16_f32 v126, v148, v149
    v_cvt_pk_bf16_f32 v127, v150, v151
    v_cvt_pk_bf16_f32 v130, v152, v153
    v_cvt_pk_bf16_f32 v131, v154, v155
    v_cvt_pk_bf16_f32 v134, v156, v157
    v_cvt_pk_bf16_f32 v135, v158, v159
    s_barrier
    ds_read_b64_tr_b16 v[8:9], v246 offset:0
    ds_read_b64_tr_b16 v[10:11], v246 offset:2048
    ds_read_b64_tr_b16 v[12:13], v247 offset:0
    ds_read_b64_tr_b16 v[14:15], v247 offset:2048
    ds_read_b64_tr_b16 v[16:17], v244 offset:0
    ds_read_b64_tr_b16 v[18:19], v244 offset:2048
    ds_read_b64_tr_b16 v[20:21], v245 offset:0
    ds_read_b64_tr_b16 v[22:23], v245 offset:2048
    ds_read_b64_tr_b16 v[24:25], v246 offset:4096
    ds_read_b64_tr_b16 v[26:27], v246 offset:6144
    s_waitcnt lgkmcnt(6)
    v_mfma_f32_16x16x32_bf16 v[208:211], v[8:11], v[40:43], 0
    ds_read_b64_tr_b16 v[28:29], v247 offset:4096
    v_mfma_f32_16x16x32_bf16 v[212:215], v[8:11], v[44:47], 0
    ds_read_b64_tr_b16 v[30:31], v247 offset:6144
    v_mfma_f32_16x16x32_bf16 v[216:219], v[8:11], v[48:51], 0
    v_mfma_f32_16x16x32_bf16 v[220:223], v[12:15], v[40:43], 0
    ds_read_b64_tr_b16 v[32:33], v244 offset:4096
    v_mfma_f32_16x16x32_bf16 v[224:227], v[12:15], v[44:47], 0
    ds_read_b64_tr_b16 v[34:35], v244 offset:6144
    v_mfma_f32_16x16x32_bf16 v[228:231], v[12:15], v[48:51], 0
    s_waitcnt lgkmcnt(6)
    v_mfma_f32_16x16x32_bf16 v[184:187], v[16:19], v[40:43], 0
    ds_read_b64_tr_b16 v[36:37], v245 offset:4096
    v_mfma_f32_16x16x32_bf16 v[188:191], v[16:19], v[44:47], 0
    ds_read_b64_tr_b16 v[38:39], v245 offset:6144
    v_mfma_f32_16x16x32_bf16 v[192:195], v[16:19], v[48:51], 0
    v_mfma_f32_16x16x32_bf16 v[196:199], v[20:23], v[40:43], 0
    ds_read_b64_tr_b16 v[8:9], v246 offset:16384
    v_mfma_f32_16x16x32_bf16 v[200:203], v[20:23], v[44:47], 0
    ds_read_b64_tr_b16 v[10:11], v246 offset:18432
    v_mfma_f32_16x16x32_bf16 v[204:207], v[20:23], v[48:51], 0
    s_waitcnt lgkmcnt(6)
    v_mfma_f32_16x16x32_bf16 v[208:211], v[24:27], v[52:55], v[208:211]
    ds_read_b64_tr_b16 v[12:13], v247 offset:16384
    v_mfma_f32_16x16x32_bf16 v[212:215], v[24:27], v[56:59], v[212:215]
    ds_read_b64_tr_b16 v[14:15], v247 offset:18432
    v_mfma_f32_16x16x32_bf16 v[216:219], v[24:27], v[60:63], v[216:219]
    v_mfma_f32_16x16x32_bf16 v[220:223], v[28:31], v[52:55], v[220:223]
    ds_read_b64_tr_b16 v[16:17], v246 offset:20480
    v_mfma_f32_16x16x32_bf16 v[224:227], v[28:31], v[56:59], v[224:227]
    ds_read_b64_tr_b16 v[18:19], v246 offset:22528
    v_mfma_f32_16x16x32_bf16 v[228:231], v[28:31], v[60:63], v[228:231]
    s_waitcnt lgkmcnt(6)
    v_mfma_f32_16x16x32_bf16 v[184:187], v[32:35], v[52:55], v[184:187]
    ds_read_b64_tr_b16 v[20:21], v247 offset:20480
    v_mfma_f32_16x16x32_bf16 v[188:191], v[32:35], v[56:59], v[188:191]
    ds_read_b64_tr_b16 v[22:23], v247 offset:22528
    v_mfma_f32_16x16x32_bf16 v[192:195], v[32:35], v[60:63], v[192:195]
    v_mfma_f32_16x16x32_bf16 v[196:199], v[36:39], v[52:55], v[196:199]
    s_barrier
    ds_read_b64_tr_b16 v[24:25], v246 offset:32768
    v_mfma_f32_16x16x32_bf16 v[200:203], v[36:39], v[56:59], v[200:203]
    ds_read_b64_tr_b16 v[26:27], v246 offset:34816
    v_mfma_f32_16x16x32_bf16 v[204:207], v[36:39], v[60:63], v[204:207]
    s_waitcnt lgkmcnt(6)
    v_mfma_f32_16x16x32_bf16 v[208:211], v[8:11], v[64:67], v[208:211]
    ds_read_b64_tr_b16 v[28:29], v247 offset:32768
    v_mfma_f32_16x16x32_bf16 v[212:215], v[8:11], v[68:71], v[212:215]
    ds_read_b64_tr_b16 v[30:31], v247 offset:34816
    v_mfma_f32_16x16x32_bf16 v[216:219], v[8:11], v[72:75], v[216:219]
    v_mfma_f32_16x16x32_bf16 v[220:223], v[12:15], v[64:67], v[220:223]
    ds_read_b64_tr_b16 v[32:33], v246 offset:36864
    v_mfma_f32_16x16x32_bf16 v[224:227], v[12:15], v[68:71], v[224:227]
    ds_read_b64_tr_b16 v[34:35], v246 offset:38912
    v_mfma_f32_16x16x32_bf16 v[228:231], v[12:15], v[72:75], v[228:231]
    s_waitcnt lgkmcnt(6)
    v_mfma_f32_16x16x32_bf16 v[208:211], v[16:19], v[76:79], v[208:211]
    ds_read_b64_tr_b16 v[36:37], v247 offset:36864
    v_mfma_f32_16x16x32_bf16 v[212:215], v[16:19], v[80:83], v[212:215]
    ds_read_b64_tr_b16 v[38:39], v247 offset:38912
    v_mfma_f32_16x16x32_bf16 v[216:219], v[16:19], v[84:87], v[216:219]
    v_mfma_f32_16x16x32_bf16 v[220:223], v[20:23], v[76:79], v[220:223]
    ds_read_b64_tr_b16 v[8:9], v246 offset:49152
    v_mfma_f32_16x16x32_bf16 v[224:227], v[20:23], v[80:83], v[224:227]
    ds_read_b64_tr_b16 v[10:11], v246 offset:51200
    v_mfma_f32_16x16x32_bf16 v[228:231], v[20:23], v[84:87], v[228:231]
    s_waitcnt lgkmcnt(6)
    v_mfma_f32_16x16x32_bf16 v[208:211], v[24:27], v[88:91], v[208:211]
    ds_read_b64_tr_b16 v[12:13], v247 offset:49152
    v_mfma_f32_16x16x32_bf16 v[212:215], v[24:27], v[92:95], v[212:215]
    ds_read_b64_tr_b16 v[14:15], v247 offset:51200
    v_mfma_f32_16x16x32_bf16 v[216:219], v[24:27], v[96:99], v[216:219]
    v_mfma_f32_16x16x32_bf16 v[220:223], v[28:31], v[88:91], v[220:223]
    ds_read_b64_tr_b16 v[16:17], v246 offset:53248
    v_mfma_f32_16x16x32_bf16 v[224:227], v[28:31], v[92:95], v[224:227]
    ds_read_b64_tr_b16 v[18:19], v246 offset:55296
    v_mfma_f32_16x16x32_bf16 v[228:231], v[28:31], v[96:99], v[228:231]
    s_waitcnt lgkmcnt(6)
    v_mfma_f32_16x16x32_bf16 v[208:211], v[32:35], v[100:103], v[208:211]
    ds_read_b64_tr_b16 v[20:21], v247 offset:53248
    v_mfma_f32_16x16x32_bf16 v[212:215], v[32:35], v[104:107], v[212:215]
    ds_read_b64_tr_b16 v[22:23], v247 offset:55296
    v_mfma_f32_16x16x32_bf16 v[216:219], v[32:35], v[108:111], v[216:219]
    v_mfma_f32_16x16x32_bf16 v[220:223], v[36:39], v[100:103], v[220:223]
    ds_read_b64_tr_b16 v[24:25], v244 offset:16384
    v_mfma_f32_16x16x32_bf16 v[224:227], v[36:39], v[104:107], v[224:227]
    ds_read_b64_tr_b16 v[26:27], v244 offset:18432
    v_mfma_f32_16x16x32_bf16 v[228:231], v[36:39], v[108:111], v[228:231]
    s_waitcnt lgkmcnt(6)
    v_mfma_f32_16x16x32_bf16 v[208:211], v[8:11], v[112:115], v[208:211]
    ds_read_b64_tr_b16 v[28:29], v245 offset:16384
    v_mfma_f32_16x16x32_bf16 v[212:215], v[8:11], v[116:119], v[212:215]
    ds_read_b64_tr_b16 v[30:31], v245 offset:18432
    v_mfma_f32_16x16x32_bf16 v[216:219], v[8:11], v[120:123], v[216:219]
    v_mfma_f32_16x16x32_bf16 v[220:223], v[12:15], v[112:115], v[220:223]
    ds_read_b64_tr_b16 v[32:33], v244 offset:20480
    v_mfma_f32_16x16x32_bf16 v[224:227], v[12:15], v[116:119], v[224:227]
    ds_read_b64_tr_b16 v[34:35], v244 offset:22528
    v_mfma_f32_16x16x32_bf16 v[228:231], v[12:15], v[120:123], v[228:231]
    s_waitcnt lgkmcnt(6)
    v_mfma_f32_16x16x32_bf16 v[208:211], v[16:19], v[124:127], v[208:211]
    ds_read_b64_tr_b16 v[36:37], v245 offset:20480
    v_mfma_f32_16x16x32_bf16 v[212:215], v[16:19], v[128:131], v[212:215]
    ds_read_b64_tr_b16 v[38:39], v245 offset:22528
    v_mfma_f32_16x16x32_bf16 v[216:219], v[16:19], v[132:135], v[216:219]
    v_mfma_f32_16x16x32_bf16 v[220:223], v[20:23], v[124:127], v[220:223]
    ds_read_b64_tr_b16 v[8:9], v244 offset:32768
    v_mfma_f32_16x16x32_bf16 v[224:227], v[20:23], v[128:131], v[224:227]
    ds_read_b64_tr_b16 v[10:11], v244 offset:34816
    v_mfma_f32_16x16x32_bf16 v[228:231], v[20:23], v[132:135], v[228:231]
    s_waitcnt lgkmcnt(6)
    v_mfma_f32_16x16x32_bf16 v[184:187], v[24:27], v[64:67], v[184:187]
    ds_read_b64_tr_b16 v[12:13], v245 offset:32768
    v_perm_b32 v208, v209, v208, s12
    v_mfma_f32_16x16x32_bf16 v[188:191], v[24:27], v[68:71], v[188:191]
    ds_read_b64_tr_b16 v[14:15], v245 offset:34816
    v_perm_b32 v209, v211, v210, s12
    v_mfma_f32_16x16x32_bf16 v[192:195], v[24:27], v[72:75], v[192:195]
    v_perm_b32 v212, v213, v212, s12
    v_perm_b32 v213, v215, v214, s12
    v_mfma_f32_16x16x32_bf16 v[196:199], v[28:31], v[64:67], v[196:199]
    ds_read_b64_tr_b16 v[16:17], v244 offset:36864
    v_perm_b32 v216, v217, v216, s12
    v_mfma_f32_16x16x32_bf16 v[200:203], v[28:31], v[68:71], v[200:203]
    ds_read_b64_tr_b16 v[18:19], v244 offset:38912
    v_perm_b32 v217, v219, v218, s12
    v_mfma_f32_16x16x32_bf16 v[204:207], v[28:31], v[72:75], v[204:207]
    v_perm_b32 v220, v221, v220, s12
    s_waitcnt lgkmcnt(6)
    v_mfma_f32_16x16x32_bf16 v[184:187], v[32:35], v[76:79], v[184:187]
    ds_read_b64_tr_b16 v[20:21], v245 offset:36864
    v_perm_b32 v221, v223, v222, s12
    v_mfma_f32_16x16x32_bf16 v[188:191], v[32:35], v[80:83], v[188:191]
    ds_read_b64_tr_b16 v[22:23], v245 offset:38912
    v_perm_b32 v224, v225, v224, s12
    v_mfma_f32_16x16x32_bf16 v[192:195], v[32:35], v[84:87], v[192:195]
    v_perm_b32 v225, v227, v226, s12
    v_perm_b32 v228, v229, v228, s12
    v_mfma_f32_16x16x32_bf16 v[196:199], v[36:39], v[76:79], v[196:199]
    ds_read_b64_tr_b16 v[24:25], v244 offset:49152
    v_perm_b32 v229, v231, v230, s12
    v_mfma_f32_16x16x32_bf16 v[200:203], v[36:39], v[80:83], v[200:203]
    ds_read_b64_tr_b16 v[26:27], v244 offset:51200
    ds_write_addtid_b32 v208 offset:24576
    v_mfma_f32_16x16x32_bf16 v[204:207], v[36:39], v[84:87], v[204:207]
    ds_write_addtid_b32 v209 offset:24832
    s_waitcnt lgkmcnt(8)
    v_mfma_f32_16x16x32_bf16 v[184:187], v[8:11], v[88:91], v[184:187]
    ds_read_b64_tr_b16 v[28:29], v245 offset:49152
    ds_write_addtid_b32 v212 offset:25088
    v_mfma_f32_16x16x32_bf16 v[188:191], v[8:11], v[92:95], v[188:191]
    ds_read_b64_tr_b16 v[30:31], v245 offset:51200
    ds_write_addtid_b32 v213 offset:25344
    v_mfma_f32_16x16x32_bf16 v[192:195], v[8:11], v[96:99], v[192:195]
    ds_write_addtid_b32 v216 offset:25600
    ds_write_addtid_b32 v217 offset:25856
    v_mfma_f32_16x16x32_bf16 v[196:199], v[12:15], v[88:91], v[196:199]
    ds_read_b64_tr_b16 v[32:33], v244 offset:53248
    ds_write_addtid_b32 v220 offset:26112
    v_mfma_f32_16x16x32_bf16 v[200:203], v[12:15], v[92:95], v[200:203]
    ds_read_b64_tr_b16 v[34:35], v244 offset:55296
    ds_write_addtid_b32 v221 offset:26368
    v_mfma_f32_16x16x32_bf16 v[204:207], v[12:15], v[96:99], v[204:207]
    ds_write_addtid_b32 v224 offset:26624
    s_waitcnt lgkmcnt(15)
    v_mfma_f32_16x16x32_bf16 v[184:187], v[16:19], v[100:103], v[184:187]
    ds_read_b64_tr_b16 v[36:37], v245 offset:53248
    ds_write_addtid_b32 v225 offset:26880
    v_mfma_f32_16x16x32_bf16 v[188:191], v[16:19], v[104:107], v[188:191]
    ds_read_b64_tr_b16 v[38:39], v245 offset:55296
    ds_write_addtid_b32 v228 offset:27136
    v_mfma_f32_16x16x32_bf16 v[192:195], v[16:19], v[108:111], v[192:195]
    ds_write_addtid_b32 v229 offset:27392
    v_mfma_f32_16x16x32_bf16 v[196:199], v[20:23], v[100:103], v[196:199]
    s_waitcnt lgkmcnt(0)
    s_barrier
    ds_read_b64_tr_b16 v[8:9], v3 offset:49152
    v_mfma_f32_16x16x32_bf16 v[200:203], v[20:23], v[104:107], v[200:203]
    ds_read_b64_tr_b16 v[10:11], v3 offset:51200
    ds_read2st64_b32 v[208:209], v252 offset0:0 offset1:1
    v_mfma_f32_16x16x32_bf16 v[204:207], v[20:23], v[108:111], v[204:207]
    ds_read2st64_b32 v[212:213], v252 offset0:2 offset1:3
    v_mfma_f32_16x16x32_bf16 v[184:187], v[24:27], v[112:115], v[184:187]
    ds_read_b64_tr_b16 v[12:13], v4 offset:49152
    ds_read2st64_b32 v[216:217], v252 offset0:4 offset1:5
    v_mfma_f32_16x16x32_bf16 v[188:191], v[24:27], v[116:119], v[188:191]
    ds_read_b64_tr_b16 v[14:15], v4 offset:51200
    ds_read2st64_b32 v[220:221], v252 offset0:6 offset1:7
    v_mfma_f32_16x16x32_bf16 v[192:195], v[24:27], v[120:123], v[192:195]
    ds_read2st64_b32 v[224:225], v252 offset0:8 offset1:9
    ds_read2st64_b32 v[228:229], v252 offset0:10 offset1:11
    v_mfma_f32_16x16x32_bf16 v[196:199], v[28:31], v[112:115], v[196:199]
    ds_read_b64_tr_b16 v[16:17], v3 offset:53248
    v_mfma_f32_16x16x32_bf16 v[200:203], v[28:31], v[116:119], v[200:203]
    ds_read_b64_tr_b16 v[18:19], v3 offset:55296
    v_mfma_f32_16x16x32_bf16 v[204:207], v[28:31], v[120:123], v[204:207]
    v_mfma_f32_16x16x32_bf16 v[184:187], v[32:35], v[124:127], v[184:187]
    ds_read_b64_tr_b16 v[20:21], v4 offset:53248
    s_waitcnt lgkmcnt(7)
    v_mfma_f32_16x16x32_bf16 v[188:191], v[32:35], v[128:131], v[188:191]
    ds_read_b64_tr_b16 v[22:23], v4 offset:55296
    v_lshl_or_b32 v210, v208, 16, s13
    v_mfma_f32_16x16x32_bf16 v[192:195], v[32:35], v[132:135], v[192:195]
    v_lshl_or_b32 v211, v209, 16, s13
    v_lshl_or_b32 v214, v212, 16, s13
    v_mfma_f32_16x16x32_bf16 v[196:199], v[36:39], v[124:127], v[196:199]
    ds_read_b64_tr_b16 v[24:25], v3 offset:32768
    v_lshl_or_b32 v215, v213, 16, s13
    v_mfma_f32_16x16x32_bf16 v[200:203], v[36:39], v[128:131], v[200:203]
    ds_read_b64_tr_b16 v[26:27], v3 offset:34816
    v_lshl_or_b32 v218, v216, 16, s13
    v_mfma_f32_16x16x32_bf16 v[204:207], v[36:39], v[132:135], v[204:207]
    v_lshl_or_b32 v219, v217, 16, s13
L_p4:
    s_waitcnt lgkmcnt(9)
    v_mfma_f32_16x16x32_bf16 v[160:163], v[8:11], v[40:43], 0
    ds_read_b64_tr_b16 v[28:29], v4 offset:32768
    s_waitcnt lgkmcnt(7)
    v_mfma_f32_16x16x32_bf16 v[164:167], v[8:11], v[44:47], 0
    ds_read_b64_tr_b16 v[30:31], v4 offset:34816
    v_lshl_or_b32 v222, v220, 16, s13
    v_mfma_f32_16x16x32_bf16 v[168:171], v[8:11], v[48:51], 0
    v_lshl_or_b32 v223, v221, 16, s13
    v_lshl_or_b32 v226, v224, 16, s13
    v_mfma_f32_16x16x32_bf16 v[172:175], v[12:15], v[40:43], 0
    ds_read_b64_tr_b16 v[32:33], v3 offset:36864
    v_lshl_or_b32 v227, v225, 16, s13
    v_mfma_f32_16x16x32_bf16 v[176:179], v[12:15], v[44:47], 0
    ds_read_b64_tr_b16 v[34:35], v3 offset:38912
    v_lshl_or_b32 v230, v228, 16, s13
    v_mfma_f32_16x16x32_bf16 v[180:183], v[12:15], v[48:51], 0
    v_lshl_or_b32 v231, v229, 16, s13
    s_waitcnt lgkmcnt(6)
    v_mfma_f32_16x16x32_bf16 v[160:163], v[16:19], v[52:55], v[160:163]
    ds_read_b64_tr_b16 v[36:37], v4 offset:36864
    v_add_f32 v184, v184, v210
    v_mfma_f32_16x16x32_bf16 v[164:167], v[16:19], v[56:59], v[164:167]
    ds_read_b64_tr_b16 v[38:39], v4 offset:38912
    v_add_f32 v185, v185, v208
    v_mfma_f32_16x16x32_bf16 v[168:171], v[16:19], v[60:63], v[168:171]
    v_add_f32 v186, v186, v211
    v_add_f32 v187, v187, v209
    v_mfma_f32_16x16x32_bf16 v[172:175], v[20:23], v[52:55], v[172:175]
    ds_read_b64_tr_b16 v[8:9], v3 offset:16384
    v_add_f32 v196, v196, v222
    v_mfma_f32_16x16x32_bf16 v[176:179], v[20:23], v[56:59], v[176:179]
    ds_read_b64_tr_b16 v[10:11], v3 offset:18432
    v_add_f32 v197, v197, v220
    v_mfma_f32_16x16x32_bf16 v[180:183], v[20:23], v[60:63], v[180:183]
    v_add_f32 v198, v198, v223
    s_waitcnt lgkmcnt(6)
    v_mfma_f32_16x16x32_bf16 v[160:163], v[24:27], v[64:67], v[160:163]
    ds_read_b64_tr_b16 v[12:13], v4 offset:16384
    v_add_f32 v199, v199, v221
    v_mfma_f32_16x16x32_bf16 v[164:167], v[24:27], v[68:71], v[164:167]
    ds_read_b64_tr_b16 v[14:15], v4 offset:18432
    v_perm_b32 v232, v185, v184, s12
    v_mfma_f32_16x16x32_bf16 v[168:171], v[24:27], v[72:75], v[168:171]
    v_perm_b32 v233, v187, v186, s12
    v_perm_b32 v234, v197, v196, s12
    v_mfma_f32_16x16x32_bf16 v[172:175], v[28:31], v[64:67], v[172:175]
    ds_read_b64_tr_b16 v[16:17], v3 offset:20480
    v_perm_b32 v235, v199, v198, s12
    v_mfma_f32_16x16x32_bf16 v[176:179], v[28:31], v[68:71], v[176:179]
    ds_read_b64_tr_b16 v[18:19], v3 offset:22528
    v_bfi_b32 v232, s15, v248, v232
    v_mfma_f32_16x16x32_bf16 v[180:183], v[28:31], v[72:75], v[180:183]
    v_bfi_b32 v233, s15, v249, v233
    s_waitcnt lgkmcnt(6)
    v_mfma_f32_16x16x32_bf16 v[160:163], v[32:35], v[76:79], v[160:163]
    ds_read_b64_tr_b16 v[20:21], v4 offset:20480
    v_bfi_b32 v234, s15, v250, v234
    v_mfma_f32_16x16x32_bf16 v[164:167], v[32:35], v[80:83], v[164:167]
    ds_read_b64_tr_b16 v[22:23], v4 offset:22528
    v_bfi_b32 v235, s15, v251, v235
    v_mfma_f32_16x16x32_bf16 v[168:171], v[32:35], v[84:87], v[168:171]
    v_add_f32 v188, v188, v214
    v_add_f32 v189, v189, v212
    v_mfma_f32_16x16x32_bf16 v[172:175], v[36:39], v[76:79], v[172:175]
    ds_read_b64_tr_b16 v[24:25], v3 offset:0
    v_add_f32 v190, v190, v215
    v_mfma_f32_16x16x32_bf16 v[176:179], v[36:39], v[80:83], v[176:179]
    ds_read_b64_tr_b16 v[26:27], v3 offset:2048
    v_add_f32 v191, v191, v213
    v_mfma_f32_16x16x32_bf16 v[180:183], v[36:39], v[84:87], v[180:183]
    v_add_f32 v200, v200, v226
    s_waitcnt lgkmcnt(6)
    v_mfma_f32_16x16x32_bf16 v[160:163], v[8:11], v[88:91], v[160:163]
    ds_read_b64_tr_b16 v[28:29], v4 offset:0
    v_add_f32 v201, v201, v224
    v_mfma_f32_16x16x32_bf16 v[164:167], v[8:11], v[92:95], v[164:167]
    ds_read_b64_tr_b16 v[30:31], v4 offset:2048
    v_add_f32 v202, v202, v227
    v_mfma_f32_16x16x32_bf16 v[168:171], v[8:11], v[96:99], v[168:171]
    v_add_f32 v203, v203, v225
    v_perm_b32 v236, v189, v188, s12
    v_mfma_f32_16x16x32_bf16 v[172:175], v[12:15], v[88:91], v[172:175]
    ds_read_b64_tr_b16 v[32:33], v3 offset:4096
    v_perm_b32 v237, v191, v190, s12
    v_mfma_f32_16x16x32_bf16 v[176:179], v[12:15], v[92:95], v[176:179]
    ds_read_b64_tr_b16 v[34:35], v3 offset:6144
    v_perm_b32 v238, v201, v200, s12
    v_mfma_f32_16x16x32_bf16 v[180:183], v[12:15], v[96:99], v[180:183]
    v_perm_b32 v239, v203, v202, s12
    s_waitcnt lgkmcnt(6)
    v_mfma_f32_16x16x32_bf16 v[160:163], v[16:19], v[100:103], v[160:163]
    ds_read_b64_tr_b16 v[36:37], v4 offset:4096
    v_bfi_b32 v236, s15, v248, v236
    v_mfma_f32_16x16x32_bf16 v[164:167], v[16:19], v[104:107], v[164:167]
    ds_read_b64_tr_b16 v[38:39], v4 offset:6144
    v_bfi_b32 v237, s15, v249, v237
    v_mfma_f32_16x16x32_bf16 v[168:171], v[16:19], v[108:111], v[168:171]
    v_bfi_b32 v238, s15, v250, v238
    v_bfi_b32 v239, s15, v251, v239
    v_mfma_f32_16x16x32_bf16 v[172:175], v[20:23], v[100:103], v[172:175]
    ds_read_b64_tr_b16 v[8:9], v1 offset:49152
    v_add_f32 v192, v192, v218
    v_mfma_f32_16x16x32_bf16 v[176:179], v[20:23], v[104:107], v[176:179]
    ds_read_b64_tr_b16 v[10:11], v1 offset:51200
    v_add_f32 v193, v193, v216
    v_mfma_f32_16x16x32_bf16 v[180:183], v[20:23], v[108:111], v[180:183]
    v_add_f32 v194, v194, v219
    s_waitcnt lgkmcnt(6)
    v_mfma_f32_16x16x32_bf16 v[160:163], v[24:27], v[112:115], v[160:163]
    ds_read_b64_tr_b16 v[12:13], v2 offset:49152
    v_add_f32 v195, v195, v217
    v_mfma_f32_16x16x32_bf16 v[164:167], v[24:27], v[116:119], v[164:167]
    ds_read_b64_tr_b16 v[14:15], v2 offset:51200
    v_add_f32 v204, v204, v230
    v_mfma_f32_16x16x32_bf16 v[168:171], v[24:27], v[120:123], v[168:171]
    v_add_f32 v205, v205, v228
    v_add_f32 v206, v206, v231
    v_mfma_f32_16x16x32_bf16 v[172:175], v[28:31], v[112:115], v[172:175]
    ds_read_b64_tr_b16 v[16:17], v1 offset:53248
    v_add_f32 v207, v207, v229
    v_mfma_f32_16x16x32_bf16 v[176:179], v[28:31], v[116:119], v[176:179]
    ds_read_b64_tr_b16 v[18:19], v1 offset:55296
    v_perm_b32 v240, v193, v192, s12
    v_mfma_f32_16x16x32_bf16 v[180:183], v[28:31], v[120:123], v[180:183]
    v_perm_b32 v241, v195, v194, s12
    s_waitcnt lgkmcnt(6)
    v_mfma_f32_16x16x32_bf16 v[160:163], v[32:35], v[124:127], v[160:163]
    ds_read_b64_tr_b16 v[20:21], v2 offset:53248
    v_perm_b32 v242, v205, v204, s12
    v_mfma_f32_16x16x32_bf16 v[164:167], v[32:35], v[128:131], v[164:167]
    ds_read_b64_tr_b16 v[22:23], v2 offset:55296
    v_perm_b32 v243, v207, v206, s12
    v_mfma_f32_16x16x32_bf16 v[168:171], v[32:35], v[132:135], v[168:171]
    v_bfi_b32 v240, s15, v248, v240
    v_bfi_b32 v241, s15, v249, v241
    v_mfma_f32_16x16x32_bf16 v[172:175], v[36:39], v[124:127], v[172:175]
    ds_read_b64_tr_b16 v[24:25], v1 offset:32768
    v_bfi_b32 v242, s15, v250, v242
    v_mfma_f32_16x16x32_bf16 v[176:179], v[36:39], v[128:131], v[176:179]
    ds_read_b64_tr_b16 v[26:27], v1 offset:34816
    v_bfi_b32 v243, s15, v251, v243
    v_mfma_f32_16x16x32_bf16 v[180:183], v[36:39], v[132:135], v[180:183]
    s_waitcnt lgkmcnt(6)
    v_mfma_f32_16x16x32_bf16 v[136:139], v[8:11], v[40:43], 0
    ds_read_b64_tr_b16 v[28:29], v2 offset:32768
    buffer_store_dwordx4 v[232:235], v254, s[64:67], s10 offen offset:0 sc1
    v_mfma_f32_16x16x32_bf16 v[140:143], v[8:11], v[44:47], 0
    ds_read_b64_tr_b16 v[30:31], v2 offset:34816
    v_mfma_f32_16x16x32_bf16 v[144:147], v[8:11], v[48:51], 0
    v_mfma_f32_16x16x32_bf16 v[148:151], v[12:15], v[40:43], 0
    ds_read_b64_tr_b16 v[32:33], v1 offset:36864
    buffer_store_dwordx4 v[236:239], v254, s[64:67], s10 offen offset:1024 sc1
    v_mfma_f32_16x16x32_bf16 v[152:155], v[12:15], v[44:47], 0
    ds_read_b64_tr_b16 v[34:35], v1 offset:38912
    v_perm_b32 v160, v161, v160, s12
    v_mfma_f32_16x16x32_bf16 v[156:159], v[12:15], v[48:51], 0
    v_perm_b32 v161, v163, v162, s12
    s_waitcnt lgkmcnt(6)
    v_mfma_f32_16x16x32_bf16 v[136:139], v[16:19], v[52:55], v[136:139]
    ds_read_b64_tr_b16 v[36:37], v2 offset:36864
    buffer_store_dwordx4 v[240:243], v254, s[64:67], s10 offen offset:2048 sc1
    v_mfma_f32_16x16x32_bf16 v[140:143], v[16:19], v[56:59], v[140:143]
    ds_read_b64_tr_b16 v[38:39], v2 offset:38912
    s_add_u32 s10, s10, 16384
    v_mfma_f32_16x16x32_bf16 v[144:147], v[16:19], v[60:63], v[144:147]
    v_perm_b32 v164, v165, v164, s12
    v_perm_b32 v165, v167, v166, s12
    v_mfma_f32_16x16x32_bf16 v[148:151], v[20:23], v[52:55], v[148:151]
    ds_read_b64_tr_b16 v[8:9], v1 offset:16384
    v_perm_b32 v168, v169, v168, s12
    v_mfma_f32_16x16x32_bf16 v[152:155], v[20:23], v[56:59], v[152:155]
    ds_read_b64_tr_b16 v[10:11], v1 offset:18432
    v_perm_b32 v169, v171, v170, s12
    v_mfma_f32_16x16x32_bf16 v[156:159], v[20:23], v[60:63], v[156:159]
    v_perm_b32 v172, v173, v172, s12
    s_waitcnt lgkmcnt(6)
    v_mfma_f32_16x16x32_bf16 v[136:139], v[24:27], v[64:67], v[136:139]
    ds_read_b64_tr_b16 v[12:13], v2 offset:16384
    v_perm_b32 v173, v175, v174, s12
    v_mfma_f32_16x16x32_bf16 v[140:143], v[24:27], v[68:71], v[140:143]
    ds_read_b64_tr_b16 v[14:15], v2 offset:18432
    v_perm_b32 v176, v177, v176, s12
    v_mfma_f32_16x16x32_bf16 v[144:147], v[24:27], v[72:75], v[144:147]
    v_perm_b32 v177, v179, v178, s12
    v_perm_b32 v180, v181, v180, s12
    v_mfma_f32_16x16x32_bf16 v[148:151], v[28:31], v[64:67], v[148:151]
    ds_read_b64_tr_b16 v[16:17], v1 offset:20480
    v_perm_b32 v181, v183, v182, s12
    v_mfma_f32_16x16x32_bf16 v[152:155], v[28:31], v[68:71], v[152:155]
    ds_read_b64_tr_b16 v[18:19], v1 offset:22528
    v_mfma_f32_16x16x32_bf16 v[156:159], v[28:31], v[72:75], v[156:159]
    s_waitcnt lgkmcnt(6)
    v_mfma_f32_16x16x32_bf16 v[136:139], v[32:35], v[76:79], v[136:139]
    ds_read_b64_tr_b16 v[20:21], v2 offset:20480
    ds_write_addtid_b32 v160 offset:27648
    v_mfma_f32_16x16x32_bf16 v[140:143], v[32:35], v[80:83], v[140:143]
    ds_read_b64_tr_b16 v[22:23], v2 offset:22528
    ds_write_addtid_b32 v161 offset:27904
    v_mfma_f32_16x16x32_bf16 v[144:147], v[32:35], v[84:87], v[144:147]
    ds_write_addtid_b32 v164 offset:28160
    ds_write_addtid_b32 v165 offset:28416
    v_mfma_f32_16x16x32_bf16 v[148:151], v[36:39], v[76:79], v[148:151]
    ds_read_b64_tr_b16 v[24:25], v1 offset:0
    ds_write_addtid_b32 v168 offset:28672
    v_mfma_f32_16x16x32_bf16 v[152:155], v[36:39], v[80:83], v[152:155]
    ds_read_b64_tr_b16 v[26:27], v1 offset:2048
    ds_write_addtid_b32 v169 offset:28928
    v_mfma_f32_16x16x32_bf16 v[156:159], v[36:39], v[84:87], v[156:159]
    ds_write_addtid_b32 v172 offset:29184
    s_waitcnt lgkmcnt(13)
    v_mfma_f32_16x16x32_bf16 v[136:139], v[8:11], v[88:91], v[136:139]
    ds_read_b64_tr_b16 v[28:29], v2 offset:0
    ds_write_addtid_b32 v173 offset:29440
    v_mfma_f32_16x16x32_bf16 v[140:143], v[8:11], v[92:95], v[140:143]
    ds_read_b64_tr_b16 v[30:31], v2 offset:2048
    ds_write_addtid_b32 v176 offset:29696
    v_mfma_f32_16x16x32_bf16 v[144:147], v[8:11], v[96:99], v[144:147]
    ds_write_addtid_b32 v177 offset:29952
    ds_write_addtid_b32 v180 offset:30208
    v_mfma_f32_16x16x32_bf16 v[148:151], v[12:15], v[88:91], v[148:151]
    ds_read_b64_tr_b16 v[32:33], v1 offset:4096
    ds_write_addtid_b32 v181 offset:30464
    v_mfma_f32_16x16x32_bf16 v[152:155], v[12:15], v[92:95], v[152:155]
    ds_read_b64_tr_b16 v[34:35], v1 offset:6144
    v_mfma_f32_16x16x32_bf16 v[156:159], v[12:15], v[96:99], v[156:159]
    s_waitcnt lgkmcnt(15)
    v_mfma_f32_16x16x32_bf16 v[136:139], v[16:19], v[100:103], v[136:139]
    ds_read_b64_tr_b16 v[36:37], v2 offset:4096
    v_mfma_f32_16x16x32_bf16 v[140:143], v[16:19], v[104:107], v[140:143]
    ds_read_b64_tr_b16 v[38:39], v2 offset:6144
    v_mfma_f32_16x16x32_bf16 v[144:147], v[16:19], v[108:111], v[144:147]
    v_mfma_f32_16x16x32_bf16 v[148:151], v[20:23], v[100:103], v[148:151]
    s_waitcnt lgkmcnt(3)
    s_barrier
    ds_read_b64_tr_b16 v[8:9], v246 offset:0
    v_mfma_f32_16x16x32_bf16 v[152:155], v[20:23], v[104:107], v[152:155]
    ds_read_b64_tr_b16 v[10:11], v246 offset:2048
    ds_read2st64_b32 v[160:161], v252 offset0:12 offset1:13
    v_mfma_f32_16x16x32_bf16 v[156:159], v[20:23], v[108:111], v[156:159]
    ds_read2st64_b32 v[164:165], v252 offset0:14 offset1:15
    v_mfma_f32_16x16x32_bf16 v[136:139], v[24:27], v[112:115], v[136:139]
    ds_read_b64_tr_b16 v[12:13], v247 offset:0
    ds_read2st64_b32 v[168:169], v252 offset0:16 offset1:17
    v_mfma_f32_16x16x32_bf16 v[140:143], v[24:27], v[116:119], v[140:143]
    ds_read_b64_tr_b16 v[14:15], v247 offset:2048
    ds_read2st64_b32 v[172:173], v252 offset0:18 offset1:19
    v_mfma_f32_16x16x32_bf16 v[144:147], v[24:27], v[120:123], v[144:147]
    ds_read2st64_b32 v[176:177], v252 offset0:20 offset1:21
    ds_read2st64_b32 v[180:181], v252 offset0:22 offset1:23
    v_mfma_f32_16x16x32_bf16 v[148:151], v[28:31], v[112:115], v[148:151]
    ds_read_b64_tr_b16 v[16:17], v246 offset:4096
    v_mfma_f32_16x16x32_bf16 v[152:155], v[28:31], v[116:119], v[152:155]
    ds_read_b64_tr_b16 v[18:19], v246 offset:6144
    v_mfma_f32_16x16x32_bf16 v[156:159], v[28:31], v[120:123], v[156:159]
    s_waitcnt lgkmcnt(12)
    v_mfma_f32_16x16x32_bf16 v[136:139], v[32:35], v[124:127], v[136:139]
    ds_read_b64_tr_b16 v[20:21], v247 offset:4096
    s_waitcnt lgkmcnt(7)
    v_mfma_f32_16x16x32_bf16 v[140:143], v[32:35], v[128:131], v[140:143]
    ds_read_b64_tr_b16 v[22:23], v247 offset:6144
    v_lshl_or_b32 v162, v160, 16, s13
    v_mfma_f32_16x16x32_bf16 v[144:147], v[32:35], v[132:135], v[144:147]
    v_lshl_or_b32 v163, v161, 16, s13
    v_lshl_or_b32 v166, v164, 16, s13
    v_mfma_f32_16x16x32_bf16 v[148:151], v[36:39], v[124:127], v[148:151]
    ds_read_b64_tr_b16 v[24:25], v246 offset:16384
    v_lshl_or_b32 v167, v165, 16, s13
    v_mfma_f32_16x16x32_bf16 v[152:155], v[36:39], v[128:131], v[152:155]
    ds_read_b64_tr_b16 v[26:27], v246 offset:18432
    v_lshl_or_b32 v170, v168, 16, s13
    v_mfma_f32_16x16x32_bf16 v[156:159], v[36:39], v[132:135], v[156:159]
    v_lshl_or_b32 v171, v169, 16, s13
    s_waitcnt lgkmcnt(9)
    v_mfma_f32_16x16x32_bf16 v[208:211], v[8:11], v[40:43], 0
    ds_read_b64_tr_b16 v[28:29], v247 offset:16384
    s_waitcnt lgkmcnt(7)
    v_mfma_f32_16x16x32_bf16 v[212:215], v[8:11], v[44:47], 0
    ds_read_b64_tr_b16 v[30:31], v247 offset:18432
    v_lshl_or_b32 v174, v172, 16, s13
    v_mfma_f32_16x16x32_bf16 v[216:219], v[8:11], v[48:51], 0
    v_lshl_or_b32 v175, v173, 16, s13
    v_lshl_or_b32 v178, v176, 16, s13
    v_mfma_f32_16x16x32_bf16 v[220:223], v[12:15], v[40:43], 0
    ds_read_b64_tr_b16 v[32:33], v246 offset:20480
    v_lshl_or_b32 v179, v177, 16, s13
    v_mfma_f32_16x16x32_bf16 v[224:227], v[12:15], v[44:47], 0
    ds_read_b64_tr_b16 v[34:35], v246 offset:22528
    v_lshl_or_b32 v182, v180, 16, s13
    v_mfma_f32_16x16x32_bf16 v[228:231], v[12:15], v[48:51], 0
    v_lshl_or_b32 v183, v181, 16, s13
    s_waitcnt lgkmcnt(6)
    v_mfma_f32_16x16x32_bf16 v[208:211], v[16:19], v[52:55], v[208:211]
    ds_read_b64_tr_b16 v[36:37], v247 offset:20480
    v_add_f32 v136, v136, v162
    v_mfma_f32_16x16x32_bf16 v[212:215], v[16:19], v[56:59], v[212:215]
    ds_read_b64_tr_b16 v[38:39], v247 offset:22528
    v_add_f32 v137, v137, v160
    v_mfma_f32_16x16x32_bf16 v[216:219], v[16:19], v[60:63], v[216:219]
    v_add_f32 v138, v138, v163
    v_add_f32 v139, v139, v161
    v_mfma_f32_16x16x32_bf16 v[220:223], v[20:23], v[52:55], v[220:223]
    ds_read_b64_tr_b16 v[8:9], v246 offset:32768
    v_add_f32 v148, v148, v174
    v_mfma_f32_16x16x32_bf16 v[224:227], v[20:23], v[56:59], v[224:227]
    ds_read_b64_tr_b16 v[10:11], v246 offset:34816
    v_add_f32 v149, v149, v172
    v_mfma_f32_16x16x32_bf16 v[228:231], v[20:23], v[60:63], v[228:231]
    v_add_f32 v150, v150, v175
    s_waitcnt lgkmcnt(6)
    v_mfma_f32_16x16x32_bf16 v[208:211], v[24:27], v[64:67], v[208:211]
    ds_read_b64_tr_b16 v[12:13], v247 offset:32768
    v_add_f32 v151, v151, v173
    v_mfma_f32_16x16x32_bf16 v[212:215], v[24:27], v[68:71], v[212:215]
    ds_read_b64_tr_b16 v[14:15], v247 offset:34816
    v_perm_b32 v232, v137, v136, s12
    v_mfma_f32_16x16x32_bf16 v[216:219], v[24:27], v[72:75], v[216:219]
    v_perm_b32 v233, v139, v138, s12
    v_perm_b32 v234, v149, v148, s12
    v_mfma_f32_16x16x32_bf16 v[220:223], v[28:31], v[64:67], v[220:223]
    ds_read_b64_tr_b16 v[16:17], v246 offset:36864
    v_perm_b32 v235, v151, v150, s12
    v_mfma_f32_16x16x32_bf16 v[224:227], v[28:31], v[68:71], v[224:227]
    ds_read_b64_tr_b16 v[18:19], v246 offset:38912
    v_bfi_b32 v232, s15, v248, v232
    v_mfma_f32_16x16x32_bf16 v[228:231], v[28:31], v[72:75], v[228:231]
    v_bfi_b32 v233, s15, v249, v233
    s_waitcnt lgkmcnt(6)
    v_mfma_f32_16x16x32_bf16 v[208:211], v[32:35], v[76:79], v[208:211]
    ds_read_b64_tr_b16 v[20:21], v247 offset:36864
    v_bfi_b32 v234, s15, v250, v234
    v_mfma_f32_16x16x32_bf16 v[212:215], v[32:35], v[80:83], v[212:215]
    ds_read_b64_tr_b16 v[22:23], v247 offset:38912
    v_bfi_b32 v235, s15, v251, v235
    v_mfma_f32_16x16x32_bf16 v[216:219], v[32:35], v[84:87], v[216:219]
    v_add_f32 v140, v140, v166
    v_add_f32 v141, v141, v164
    v_mfma_f32_16x16x32_bf16 v[220:223], v[36:39], v[76:79], v[220:223]
    ds_read_b64_tr_b16 v[24:25], v246 offset:49152
    v_add_f32 v142, v142, v167
    v_mfma_f32_16x16x32_bf16 v[224:227], v[36:39], v[80:83], v[224:227]
    ds_read_b64_tr_b16 v[26:27], v246 offset:51200
    v_add_f32 v143, v143, v165
    v_mfma_f32_16x16x32_bf16 v[228:231], v[36:39], v[84:87], v[228:231]
    v_add_f32 v152, v152, v178
    s_waitcnt lgkmcnt(6)
    v_mfma_f32_16x16x32_bf16 v[208:211], v[8:11], v[88:91], v[208:211]
    ds_read_b64_tr_b16 v[28:29], v247 offset:49152
    v_add_f32 v153, v153, v176
    v_mfma_f32_16x16x32_bf16 v[212:215], v[8:11], v[92:95], v[212:215]
    ds_read_b64_tr_b16 v[30:31], v247 offset:51200
    v_add_f32 v154, v154, v179
    v_mfma_f32_16x16x32_bf16 v[216:219], v[8:11], v[96:99], v[216:219]
    v_add_f32 v155, v155, v177
    v_perm_b32 v236, v141, v140, s12
    v_mfma_f32_16x16x32_bf16 v[220:223], v[12:15], v[88:91], v[220:223]
    ds_read_b64_tr_b16 v[32:33], v246 offset:53248
    v_perm_b32 v237, v143, v142, s12
    v_mfma_f32_16x16x32_bf16 v[224:227], v[12:15], v[92:95], v[224:227]
    ds_read_b64_tr_b16 v[34:35], v246 offset:55296
    v_perm_b32 v238, v153, v152, s12
    v_mfma_f32_16x16x32_bf16 v[228:231], v[12:15], v[96:99], v[228:231]
    v_perm_b32 v239, v155, v154, s12
    s_waitcnt lgkmcnt(6)
    v_mfma_f32_16x16x32_bf16 v[208:211], v[16:19], v[100:103], v[208:211]
    ds_read_b64_tr_b16 v[36:37], v247 offset:53248
    v_bfi_b32 v236, s15, v248, v236
    v_mfma_f32_16x16x32_bf16 v[212:215], v[16:19], v[104:107], v[212:215]
    ds_read_b64_tr_b16 v[38:39], v247 offset:55296
    v_bfi_b32 v237, s15, v249, v237
    v_mfma_f32_16x16x32_bf16 v[216:219], v[16:19], v[108:111], v[216:219]
    v_bfi_b32 v238, s15, v250, v238
    v_bfi_b32 v239, s15, v251, v239
    v_mfma_f32_16x16x32_bf16 v[220:223], v[20:23], v[100:103], v[220:223]
    ds_read_b64_tr_b16 v[8:9], v244 offset:0
    v_add_f32 v144, v144, v170
    v_mfma_f32_16x16x32_bf16 v[224:227], v[20:23], v[104:107], v[224:227]
    ds_read_b64_tr_b16 v[10:11], v244 offset:2048
    v_add_f32 v145, v145, v168
    v_mfma_f32_16x16x32_bf16 v[228:231], v[20:23], v[108:111], v[228:231]
    v_add_f32 v146, v146, v171
    s_waitcnt lgkmcnt(6)
    v_mfma_f32_16x16x32_bf16 v[208:211], v[24:27], v[112:115], v[208:211]
    ds_read_b64_tr_b16 v[12:13], v245 offset:0
    v_add_f32 v147, v147, v169
    v_mfma_f32_16x16x32_bf16 v[212:215], v[24:27], v[116:119], v[212:215]
    ds_read_b64_tr_b16 v[14:15], v245 offset:2048
    v_add_f32 v156, v156, v182
    v_mfma_f32_16x16x32_bf16 v[216:219], v[24:27], v[120:123], v[216:219]
    v_add_f32 v157, v157, v180
    v_add_f32 v158, v158, v183
    v_mfma_f32_16x16x32_bf16 v[220:223], v[28:31], v[112:115], v[220:223]
    ds_read_b64_tr_b16 v[16:17], v244 offset:4096
    v_add_f32 v159, v159, v181
    v_mfma_f32_16x16x32_bf16 v[224:227], v[28:31], v[116:119], v[224:227]
    ds_read_b64_tr_b16 v[18:19], v244 offset:6144
    v_perm_b32 v240, v145, v144, s12
    v_mfma_f32_16x16x32_bf16 v[228:231], v[28:31], v[120:123], v[228:231]
    v_perm_b32 v241, v147, v146, s12
    s_waitcnt lgkmcnt(6)
    v_mfma_f32_16x16x32_bf16 v[208:211], v[32:35], v[124:127], v[208:211]
    ds_read_b64_tr_b16 v[20:21], v245 offset:4096
    v_perm_b32 v242, v157, v156, s12
    v_mfma_f32_16x16x32_bf16 v[212:215], v[32:35], v[128:131], v[212:215]
    ds_read_b64_tr_b16 v[22:23], v245 offset:6144
    v_perm_b32 v243, v159, v158, s12
    v_mfma_f32_16x16x32_bf16 v[216:219], v[32:35], v[132:135], v[216:219]
    v_bfi_b32 v240, s15, v248, v240
    v_bfi_b32 v241, s15, v249, v241
    v_mfma_f32_16x16x32_bf16 v[220:223], v[36:39], v[124:127], v[220:223]
    ds_read_b64_tr_b16 v[24:25], v244 offset:16384
    v_bfi_b32 v242, s15, v250, v242
    v_mfma_f32_16x16x32_bf16 v[224:227], v[36:39], v[128:131], v[224:227]
    ds_read_b64_tr_b16 v[26:27], v244 offset:18432
    v_bfi_b32 v243, s15, v251, v243
    v_mfma_f32_16x16x32_bf16 v[228:231], v[36:39], v[132:135], v[228:231]
    s_waitcnt lgkmcnt(6)
    v_mfma_f32_16x16x32_bf16 v[184:187], v[8:11], v[40:43], 0
    ds_read_b64_tr_b16 v[28:29], v245 offset:16384
    buffer_store_dwordx4 v[232:235], v254, s[64:67], s10 offen offset:0 sc1
    v_mfma_f32_16x16x32_bf16 v[188:191], v[8:11], v[44:47], 0
    ds_read_b64_tr_b16 v[30:31], v245 offset:18432
    v_mfma_f32_16x16x32_bf16 v[192:195], v[8:11], v[48:51], 0
    v_mfma_f32_16x16x32_bf16 v[196:199], v[12:15], v[40:43], 0
    ds_read_b64_tr_b16 v[32:33], v244 offset:20480
    buffer_store_dwordx4 v[236:239], v254, s[64:67], s10 offen offset:1024 sc1
    v_mfma_f32_16x16x32_bf16 v[200:203], v[12:15], v[44:47], 0
    ds_read_b64_tr_b16 v[34:35], v244 offset:22528
    v_perm_b32 v208, v209, v208, s12
    v_mfma_f32_16x16x32_bf16 v[204:207], v[12:15], v[48:51], 0
    v_perm_b32 v209, v211, v210, s12
    s_waitcnt lgkmcnt(6)
    v_mfma_f32_16x16x32_bf16 v[184:187], v[16:19], v[52:55], v[184:187]
    ds_read_b64_tr_b16 v[36:37], v245 offset:20480
    buffer_store_dwordx4 v[240:243], v254, s[64:67], s10 offen offset:2048 sc1
    v_mfma_f32_16x16x32_bf16 v[188:191], v[16:19], v[56:59], v[188:191]
    ds_read_b64_tr_b16 v[38:39], v245 offset:22528
    s_add_u32 s10, s10, 16384
    v_mfma_f32_16x16x32_bf16 v[192:195], v[16:19], v[60:63], v[192:195]
    v_perm_b32 v212, v213, v212, s12
    v_perm_b32 v213, v215, v214, s12
    v_mfma_f32_16x16x32_bf16 v[196:199], v[20:23], v[52:55], v[196:199]
    ds_read_b64_tr_b16 v[8:9], v244 offset:32768
    v_perm_b32 v216, v217, v216, s12
    v_mfma_f32_16x16x32_bf16 v[200:203], v[20:23], v[56:59], v[200:203]
    ds_read_b64_tr_b16 v[10:11], v244 offset:34816
    v_perm_b32 v217, v219, v218, s12
    v_mfma_f32_16x16x32_bf16 v[204:207], v[20:23], v[60:63], v[204:207]
    v_perm_b32 v220, v221, v220, s12
    s_waitcnt lgkmcnt(6)
    v_mfma_f32_16x16x32_bf16 v[184:187], v[24:27], v[64:67], v[184:187]
    ds_read_b64_tr_b16 v[12:13], v245 offset:32768
    v_perm_b32 v221, v223, v222, s12
    v_mfma_f32_16x16x32_bf16 v[188:191], v[24:27], v[68:71], v[188:191]
    ds_read_b64_tr_b16 v[14:15], v245 offset:34816
    v_perm_b32 v224, v225, v224, s12
    v_mfma_f32_16x16x32_bf16 v[192:195], v[24:27], v[72:75], v[192:195]
    v_perm_b32 v225, v227, v226, s12
    v_perm_b32 v228, v229, v228, s12
    v_mfma_f32_16x16x32_bf16 v[196:199], v[28:31], v[64:67], v[196:199]
    ds_read_b64_tr_b16 v[16:17], v244 offset:36864
    v_perm_b32 v229, v231, v230, s12
    v_mfma_f32_16x16x32_bf16 v[200:203], v[28:31], v[68:71], v[200:203]
    ds_read_b64_tr_b16 v[18:19], v244 offset:38912
    v_mfma_f32_16x16x32_bf16 v[204:207], v[28:31], v[72:75], v[204:207]
    s_waitcnt lgkmcnt(6)
    v_mfma_f32_16x16x32_bf16 v[184:187], v[32:35], v[76:79], v[184:187]
    ds_read_b64_tr_b16 v[20:21], v245 offset:36864
    ds_write_addtid_b32 v208 offset:24576
    v_mfma_f32_16x16x32_bf16 v[188:191], v[32:35], v[80:83], v[188:191]
    ds_read_b64_tr_b16 v[22:23], v245 offset:38912
    ds_write_addtid_b32 v209 offset:24832
    v_mfma_f32_16x16x32_bf16 v[192:195], v[32:35], v[84:87], v[192:195]
    ds_write_addtid_b32 v212 offset:25088
    ds_write_addtid_b32 v213 offset:25344
    v_mfma_f32_16x16x32_bf16 v[196:199], v[36:39], v[76:79], v[196:199]
    ds_read_b64_tr_b16 v[24:25], v244 offset:49152
    ds_write_addtid_b32 v216 offset:25600
    v_mfma_f32_16x16x32_bf16 v[200:203], v[36:39], v[80:83], v[200:203]
    ds_read_b64_tr_b16 v[26:27], v244 offset:51200
    ds_write_addtid_b32 v217 offset:25856
    v_mfma_f32_16x16x32_bf16 v[204:207], v[36:39], v[84:87], v[204:207]
    ds_write_addtid_b32 v220 offset:26112
    s_waitcnt lgkmcnt(13)
    v_mfma_f32_16x16x32_bf16 v[184:187], v[8:11], v[88:91], v[184:187]
    ds_read_b64_tr_b16 v[28:29], v245 offset:49152
    ds_write_addtid_b32 v221 offset:26368
    v_mfma_f32_16x16x32_bf16 v[188:191], v[8:11], v[92:95], v[188:191]
    ds_read_b64_tr_b16 v[30:31], v245 offset:51200
    ds_write_addtid_b32 v224 offset:26624
    v_mfma_f32_16x16x32_bf16 v[192:195], v[8:11], v[96:99], v[192:195]
    ds_write_addtid_b32 v225 offset:26880
    ds_write_addtid_b32 v228 offset:27136
    v_mfma_f32_16x16x32_bf16 v[196:199], v[12:15], v[88:91], v[196:199]
    ds_read_b64_tr_b16 v[32:33], v244 offset:53248
    ds_write_addtid_b32 v229 offset:27392
    v_mfma_f32_16x16x32_bf16 v[200:203], v[12:15], v[92:95], v[200:203]
    ds_read_b64_tr_b16 v[34:35], v244 offset:55296
    v_mfma_f32_16x16x32_bf16 v[204:207], v[12:15], v[96:99], v[204:207]
    s_waitcnt lgkmcnt(15)
    v_mfma_f32_16x16x32_bf16 v[184:187], v[16:19], v[100:103], v[184:187]
    ds_read_b64_tr_b16 v[36:37], v245 offset:53248
    v_mfma_f32_16x16x32_bf16 v[188:191], v[16:19], v[104:107], v[188:191]
    ds_read_b64_tr_b16 v[38:39], v245 offset:55296
    v_mfma_f32_16x16x32_bf16 v[192:195], v[16:19], v[108:111], v[192:195]
    v_mfma_f32_16x16x32_bf16 v[196:199], v[20:23], v[100:103], v[196:199]
    s_waitcnt lgkmcnt(3)
    s_barrier
    ds_read_b64_tr_b16 v[8:9], v3 offset:49152
    v_mfma_f32_16x16x32_bf16 v[200:203], v[20:23], v[104:107], v[200:203]
    ds_read_b64_tr_b16 v[10:11], v3 offset:51200
    ds_read2st64_b32 v[208:209], v252 offset0:0 offset1:1
    v_mfma_f32_16x16x32_bf16 v[204:207], v[20:23], v[108:111], v[204:207]
    ds_read2st64_b32 v[212:213], v252 offset0:2 offset1:3
    v_mfma_f32_16x16x32_bf16 v[184:187], v[24:27], v[112:115], v[184:187]
    ds_read_b64_tr_b16 v[12:13], v4 offset:49152
    ds_read2st64_b32 v[216:217], v252 offset0:4 offset1:5
    v_mfma_f32_16x16x32_bf16 v[188:191], v[24:27], v[116:119], v[188:191]
    ds_read_b64_tr_b16 v[14:15], v4 offset:51200
    ds_read2st64_b32 v[220:221], v252 offset0:6 offset1:7
    v_mfma_f32_16x16x32_bf16 v[192:195], v[24:27], v[120:123], v[192:195]
    ds_read2st64_b32 v[224:225], v252 offset0:8 offset1:9
    ds_read2st64_b32 v[228:229], v252 offset0:10 offset1:11
    v_mfma_f32_16x16x32_bf16 v[196:199], v[28:31], v[112:115], v[196:199]
    ds_read_b64_tr_b16 v[16:17], v3 offset:53248
    v_mfma_f32_16x16x32_bf16 v[200:203], v[28:31], v[116:119], v[200:203]
    ds_read_b64_tr_b16 v[18:19], v3 offset:55296
    v_mfma_f32_16x16x32_bf16 v[204:207], v[28:31], v[120:123], v[204:207]
    s_waitcnt lgkmcnt(12)
    v_mfma_f32_16x16x32_bf16 v[184:187], v[32:35], v[124:127], v[184:187]
    ds_read_b64_tr_b16 v[20:21], v4 offset:53248
    s_waitcnt lgkmcnt(7)
    v_mfma_f32_16x16x32_bf16 v[188:191], v[32:35], v[128:131], v[188:191]
    ds_read_b64_tr_b16 v[22:23], v4 offset:55296
    v_lshl_or_b32 v210, v208, 16, s13
    v_mfma_f32_16x16x32_bf16 v[192:195], v[32:35], v[132:135], v[192:195]
    v_lshl_or_b32 v211, v209, 16, s13
    v_lshl_or_b32 v214, v212, 16, s13
    v_mfma_f32_16x16x32_bf16 v[196:199], v[36:39], v[124:127], v[196:199]
    ds_read_b64_tr_b16 v[24:25], v3 offset:32768
    v_lshl_or_b32 v215, v213, 16, s13
    v_mfma_f32_16x16x32_bf16 v[200:203], v[36:39], v[128:131], v[200:203]
    ds_read_b64_tr_b16 v[26:27], v3 offset:34816
    v_lshl_or_b32 v218, v216, 16, s13
    v_mfma_f32_16x16x32_bf16 v[204:207], v[36:39], v[132:135], v[204:207]
    v_lshl_or_b32 v219, v217, 16, s13
    s_add_u32 s6, s6, 1
    s_cmp_lt_u32 s6, 2
    s_cbranch_scc1 L_p4
    s_waitcnt lgkmcnt(9)
    v_mfma_f32_16x16x32_bf16 v[160:163], v[8:11], v[40:43], 0
    ds_read_b64_tr_b16 v[28:29], v4 offset:32768
    s_waitcnt lgkmcnt(7)
    v_mfma_f32_16x16x32_bf16 v[164:167], v[8:11], v[44:47], 0
    ds_read_b64_tr_b16 v[30:31], v4 offset:34816
    v_lshl_or_b32 v222, v220, 16, s13
    v_mfma_f32_16x16x32_bf16 v[168:171], v[8:11], v[48:51], 0
    v_lshl_or_b32 v223, v221, 16, s13
    v_lshl_or_b32 v226, v224, 16, s13
    v_mfma_f32_16x16x32_bf16 v[172:175], v[12:15], v[40:43], 0
    ds_read_b64_tr_b16 v[32:33], v3 offset:36864
    v_lshl_or_b32 v227, v225, 16, s13
    v_mfma_f32_16x16x32_bf16 v[176:179], v[12:15], v[44:47], 0
    ds_read_b64_tr_b16 v[34:35], v3 offset:38912
    v_lshl_or_b32 v230, v228, 16, s13
    v_mfma_f32_16x16x32_bf16 v[180:183], v[12:15], v[48:51], 0
    v_lshl_or_b32 v231, v229, 16, s13
    s_waitcnt lgkmcnt(6)
    v_mfma_f32_16x16x32_bf16 v[160:163], v[16:19], v[52:55], v[160:163]
    ds_read_b64_tr_b16 v[36:37], v4 offset:36864
    v_add_f32 v184, v184, v210
    v_mfma_f32_16x16x32_bf16 v[164:167], v[16:19], v[56:59], v[164:167]
    ds_read_b64_tr_b16 v[38:39], v4 offset:38912
    v_add_f32 v185, v185, v208
    v_mfma_f32_16x16x32_bf16 v[168:171], v[16:19], v[60:63], v[168:171]
    v_add_f32 v186, v186, v211
    v_add_f32 v187, v187, v209
    v_mfma_f32_16x16x32_bf16 v[172:175], v[20:23], v[52:55], v[172:175]
    ds_read_b64_tr_b16 v[8:9], v3 offset:16384
    v_add_f32 v196, v196, v222
    v_mfma_f32_16x16x32_bf16 v[176:179], v[20:23], v[56:59], v[176:179]
    ds_read_b64_tr_b16 v[10:11], v3 offset:18432
    v_add_f32 v197, v197, v220
    v_mfma_f32_16x16x32_bf16 v[180:183], v[20:23], v[60:63], v[180:183]
    v_add_f32 v198, v198, v223
    s_waitcnt lgkmcnt(6)
    v_mfma_f32_16x16x32_bf16 v[160:163], v[24:27], v[64:67], v[160:163]
    ds_read_b64_tr_b16 v[12:13], v4 offset:16384
    v_add_f32 v199, v199, v221
    v_mfma_f32_16x16x32_bf16 v[164:167], v[24:27], v[68:71], v[164:167]
    ds_read_b64_tr_b16 v[14:15], v4 offset:18432
    v_perm_b32 v232, v185, v184, s12
    v_mfma_f32_16x16x32_bf16 v[168:171], v[24:27], v[72:75], v[168:171]
    v_perm_b32 v233, v187, v186, s12
    v_perm_b32 v234, v197, v196, s12
    v_mfma_f32_16x16x32_bf16 v[172:175], v[28:31], v[64:67], v[172:175]
    ds_read_b64_tr_b16 v[16:17], v3 offset:20480
    v_perm_b32 v235, v199, v198, s12
    v_mfma_f32_16x16x32_bf16 v[176:179], v[28:31], v[68:71], v[176:179]
    ds_read_b64_tr_b16 v[18:19], v3 offset:22528
    v_bfi_b32 v232, s15, v248, v232
    v_mfma_f32_16x16x32_bf16 v[180:183], v[28:31], v[72:75], v[180:183]
    v_bfi_b32 v233, s15, v249, v233
    s_waitcnt lgkmcnt(6)
    v_mfma_f32_16x16x32_bf16 v[160:163], v[32:35], v[76:79], v[160:163]
    ds_read_b64_tr_b16 v[20:21], v4 offset:20480
    v_bfi_b32 v234, s15, v250, v234
    v_mfma_f32_16x16x32_bf16 v[164:167], v[32:35], v[80:83], v[164:167]
    ds_read_b64_tr_b16 v[22:23], v4 offset:22528
    v_bfi_b32 v235, s15, v251, v235
    v_mfma_f32_16x16x32_bf16 v[168:171], v[32:35], v[84:87], v[168:171]
    v_add_f32 v188, v188, v214
    v_add_f32 v189, v189, v212
    v_mfma_f32_16x16x32_bf16 v[172:175], v[36:39], v[76:79], v[172:175]
    ds_read_b64_tr_b16 v[24:25], v3 offset:0
    v_add_f32 v190, v190, v215
    v_mfma_f32_16x16x32_bf16 v[176:179], v[36:39], v[80:83], v[176:179]
    ds_read_b64_tr_b16 v[26:27], v3 offset:2048
    v_add_f32 v191, v191, v213
    v_mfma_f32_16x16x32_bf16 v[180:183], v[36:39], v[84:87], v[180:183]
    v_add_f32 v200, v200, v226
    s_waitcnt lgkmcnt(6)
    v_mfma_f32_16x16x32_bf16 v[160:163], v[8:11], v[88:91], v[160:163]
    ds_read_b64_tr_b16 v[28:29], v4 offset:0
    v_add_f32 v201, v201, v224
    v_mfma_f32_16x16x32_bf16 v[164:167], v[8:11], v[92:95], v[164:167]
    ds_read_b64_tr_b16 v[30:31], v4 offset:2048
    v_add_f32 v202, v202, v227
    v_mfma_f32_16x16x32_bf16 v[168:171], v[8:11], v[96:99], v[168:171]
    v_add_f32 v203, v203, v225
    v_perm_b32 v236, v189, v188, s12
    v_mfma_f32_16x16x32_bf16 v[172:175], v[12:15], v[88:91], v[172:175]
    ds_read_b64_tr_b16 v[32:33], v3 offset:4096
    v_perm_b32 v237, v191, v190, s12
    v_mfma_f32_16x16x32_bf16 v[176:179], v[12:15], v[92:95], v[176:179]
    ds_read_b64_tr_b16 v[34:35], v3 offset:6144
    v_perm_b32 v238, v201, v200, s12
    v_mfma_f32_16x16x32_bf16 v[180:183], v[12:15], v[96:99], v[180:183]
    v_perm_b32 v239, v203, v202, s12
    s_waitcnt lgkmcnt(6)
    v_mfma_f32_16x16x32_bf16 v[160:163], v[16:19], v[100:103], v[160:163]
    ds_read_b64_tr_b16 v[36:37], v4 offset:4096
    v_bfi_b32 v236, s15, v248, v236
    v_mfma_f32_16x16x32_bf16 v[164:167], v[16:19], v[104:107], v[164:167]
    ds_read_b64_tr_b16 v[38:39], v4 offset:6144
    v_bfi_b32 v237, s15, v249, v237
    v_mfma_f32_16x16x32_bf16 v[168:171], v[16:19], v[108:111], v[168:171]
    v_bfi_b32 v238, s15, v250, v238
    v_bfi_b32 v239, s15, v251, v239
    v_mfma_f32_16x16x32_bf16 v[172:175], v[20:23], v[100:103], v[172:175]
    ds_read_b64_tr_b16 v[8:9], v1 offset:49152
    v_add_f32 v192, v192, v218
    v_mfma_f32_16x16x32_bf16 v[176:179], v[20:23], v[104:107], v[176:179]
    ds_read_b64_tr_b16 v[10:11], v1 offset:51200
    v_add_f32 v193, v193, v216
    v_mfma_f32_16x16x32_bf16 v[180:183], v[20:23], v[108:111], v[180:183]
    v_add_f32 v194, v194, v219
    s_waitcnt lgkmcnt(6)
    v_mfma_f32_16x16x32_bf16 v[160:163], v[24:27], v[112:115], v[160:163]
    ds_read_b64_tr_b16 v[12:13], v2 offset:49152
    v_add_f32 v195, v195, v217
    v_mfma_f32_16x16x32_bf16 v[164:167], v[24:27], v[116:119], v[164:167]
    ds_read_b64_tr_b16 v[14:15], v2 offset:51200
    v_add_f32 v204, v204, v230
    v_mfma_f32_16x16x32_bf16 v[168:171], v[24:27], v[120:123], v[168:171]
    v_add_f32 v205, v205, v228
    v_add_f32 v206, v206, v231
    v_mfma_f32_16x16x32_bf16 v[172:175], v[28:31], v[112:115], v[172:175]
    ds_read_b64_tr_b16 v[16:17], v1 offset:53248
    v_add_f32 v207, v207, v229
    v_mfma_f32_16x16x32_bf16 v[176:179], v[28:31], v[116:119], v[176:179]
    ds_read_b64_tr_b16 v[18:19], v1 offset:55296
    v_perm_b32 v240, v193, v192, s12
    v_mfma_f32_16x16x32_bf16 v[180:183], v[28:31], v[120:123], v[180:183]
    v_perm_b32 v241, v195, v194, s12
    s_waitcnt lgkmcnt(6)
    v_mfma_f32_16x16x32_bf16 v[160:163], v[32:35], v[124:127], v[160:163]
    ds_read_b64_tr_b16 v[20:21], v2 offset:53248
    v_perm_b32 v242, v205, v204, s12
    v_mfma_f32_16x16x32_bf16 v[164:167], v[32:35], v[128:131], v[164:167]
    ds_read_b64_tr_b16 v[22:23], v2 offset:55296
    v_perm_b32 v243, v207, v206, s12
    v_mfma_f32_16x16x32_bf16 v[168:171], v[32:35], v[132:135], v[168:171]
    v_bfi_b32 v240, s15, v248, v240
    v_bfi_b32 v241, s15, v249, v241
    v_mfma_f32_16x16x32_bf16 v[172:175], v[36:39], v[124:127], v[172:175]
    ds_read_b64_tr_b16 v[24:25], v1 offset:32768
    v_bfi_b32 v242, s15, v250, v242
    v_mfma_f32_16x16x32_bf16 v[176:179], v[36:39], v[128:131], v[176:179]
    ds_read_b64_tr_b16 v[26:27], v1 offset:34816
    v_bfi_b32 v243, s15, v251, v243
    v_mfma_f32_16x16x32_bf16 v[180:183], v[36:39], v[132:135], v[180:183]
    s_waitcnt lgkmcnt(6)
    v_mfma_f32_16x16x32_bf16 v[136:139], v[8:11], v[40:43], 0
    ds_read_b64_tr_b16 v[28:29], v2 offset:32768
    buffer_store_dwordx4 v[232:235], v254, s[64:67], s10 offen offset:0 sc1
    v_mfma_f32_16x16x32_bf16 v[140:143], v[8:11], v[44:47], 0
    ds_read_b64_tr_b16 v[30:31], v2 offset:34816
    v_mfma_f32_16x16x32_bf16 v[144:147], v[8:11], v[48:51], 0
    v_mfma_f32_16x16x32_bf16 v[148:151], v[12:15], v[40:43], 0
    ds_read_b64_tr_b16 v[32:33], v1 offset:36864
    buffer_store_dwordx4 v[236:239], v254, s[64:67], s10 offen offset:1024 sc1
    v_mfma_f32_16x16x32_bf16 v[152:155], v[12:15], v[44:47], 0
    ds_read_b64_tr_b16 v[34:35], v1 offset:38912
    v_perm_b32 v160, v161, v160, s12
    v_mfma_f32_16x16x32_bf16 v[156:159], v[12:15], v[48:51], 0
    v_perm_b32 v161, v163, v162, s12
    s_waitcnt lgkmcnt(6)
    v_mfma_f32_16x16x32_bf16 v[136:139], v[16:19], v[52:55], v[136:139]
    ds_read_b64_tr_b16 v[36:37], v2 offset:36864
    buffer_store_dwordx4 v[240:243], v254, s[64:67], s10 offen offset:2048 sc1
    v_mfma_f32_16x16x32_bf16 v[140:143], v[16:19], v[56:59], v[140:143]
    ds_read_b64_tr_b16 v[38:39], v2 offset:38912
    s_add_u32 s10, s10, 16384
    v_mfma_f32_16x16x32_bf16 v[144:147], v[16:19], v[60:63], v[144:147]
    v_perm_b32 v164, v165, v164, s12
    v_perm_b32 v165, v167, v166, s12
    v_mfma_f32_16x16x32_bf16 v[148:151], v[20:23], v[52:55], v[148:151]
    ds_read_b64_tr_b16 v[8:9], v1 offset:16384
    v_perm_b32 v168, v169, v168, s12
    v_mfma_f32_16x16x32_bf16 v[152:155], v[20:23], v[56:59], v[152:155]
    ds_read_b64_tr_b16 v[10:11], v1 offset:18432
    v_perm_b32 v169, v171, v170, s12
    v_mfma_f32_16x16x32_bf16 v[156:159], v[20:23], v[60:63], v[156:159]
    v_perm_b32 v172, v173, v172, s12
    s_waitcnt lgkmcnt(6)
    v_mfma_f32_16x16x32_bf16 v[136:139], v[24:27], v[64:67], v[136:139]
    ds_read_b64_tr_b16 v[12:13], v2 offset:16384
    v_perm_b32 v173, v175, v174, s12
    v_mfma_f32_16x16x32_bf16 v[140:143], v[24:27], v[68:71], v[140:143]
    ds_read_b64_tr_b16 v[14:15], v2 offset:18432
    v_perm_b32 v176, v177, v176, s12
    v_mfma_f32_16x16x32_bf16 v[144:147], v[24:27], v[72:75], v[144:147]
    v_perm_b32 v177, v179, v178, s12
    v_perm_b32 v180, v181, v180, s12
    v_mfma_f32_16x16x32_bf16 v[148:151], v[28:31], v[64:67], v[148:151]
    ds_read_b64_tr_b16 v[16:17], v1 offset:20480
    v_perm_b32 v181, v183, v182, s12
    v_mfma_f32_16x16x32_bf16 v[152:155], v[28:31], v[68:71], v[152:155]
    ds_read_b64_tr_b16 v[18:19], v1 offset:22528
    v_mfma_f32_16x16x32_bf16 v[156:159], v[28:31], v[72:75], v[156:159]
    s_waitcnt lgkmcnt(6)
    v_mfma_f32_16x16x32_bf16 v[136:139], v[32:35], v[76:79], v[136:139]
    ds_read_b64_tr_b16 v[20:21], v2 offset:20480
    ds_write_addtid_b32 v160 offset:27648
    v_mfma_f32_16x16x32_bf16 v[140:143], v[32:35], v[80:83], v[140:143]
    ds_read_b64_tr_b16 v[22:23], v2 offset:22528
    ds_write_addtid_b32 v161 offset:27904
    v_mfma_f32_16x16x32_bf16 v[144:147], v[32:35], v[84:87], v[144:147]
    ds_write_addtid_b32 v164 offset:28160
    ds_write_addtid_b32 v165 offset:28416
    v_mfma_f32_16x16x32_bf16 v[148:151], v[36:39], v[76:79], v[148:151]
    ds_read_b64_tr_b16 v[24:25], v1 offset:0
    ds_write_addtid_b32 v168 offset:28672
    v_mfma_f32_16x16x32_bf16 v[152:155], v[36:39], v[80:83], v[152:155]
    ds_read_b64_tr_b16 v[26:27], v1 offset:2048
    ds_write_addtid_b32 v169 offset:28928
    v_mfma_f32_16x16x32_bf16 v[156:159], v[36:39], v[84:87], v[156:159]
    ds_write_addtid_b32 v172 offset:29184
    s_waitcnt lgkmcnt(13)
    v_mfma_f32_16x16x32_bf16 v[136:139], v[8:11], v[88:91], v[136:139]
    ds_read_b64_tr_b16 v[28:29], v2 offset:0
    ds_write_addtid_b32 v173 offset:29440
    v_mfma_f32_16x16x32_bf16 v[140:143], v[8:11], v[92:95], v[140:143]
    ds_read_b64_tr_b16 v[30:31], v2 offset:2048
    ds_write_addtid_b32 v176 offset:29696
    v_mfma_f32_16x16x32_bf16 v[144:147], v[8:11], v[96:99], v[144:147]
    ds_write_addtid_b32 v177 offset:29952
    ds_write_addtid_b32 v180 offset:30208
    v_mfma_f32_16x16x32_bf16 v[148:151], v[12:15], v[88:91], v[148:151]
    ds_read_b64_tr_b16 v[32:33], v1 offset:4096
    ds_write_addtid_b32 v181 offset:30464
    v_mfma_f32_16x16x32_bf16 v[152:155], v[12:15], v[92:95], v[152:155]
    ds_read_b64_tr_b16 v[34:35], v1 offset:6144
    v_mfma_f32_16x16x32_bf16 v[156:159], v[12:15], v[96:99], v[156:159]
    s_waitcnt lgkmcnt(15)
    v_mfma_f32_16x16x32_bf16 v[136:139], v[16:19], v[100:103], v[136:139]
    ds_read_b64_tr_b16 v[36:37], v2 offset:4096
    v_mfma_f32_16x16x32_bf16 v[140:143], v[16:19], v[104:107], v[140:143]
    ds_read_b64_tr_b16 v[38:39], v2 offset:6144
    v_mfma_f32_16x16x32_bf16 v[144:147], v[16:19], v[108:111], v[144:147]
    v_mfma_f32_16x16x32_bf16 v[148:151], v[20:23], v[100:103], v[148:151]
    s_waitcnt lgkmcnt(3)
    s_barrier
    ds_read_b64_tr_b16 v[8:9], v246 offset:0
    v_mfma_f32_16x16x32_bf16 v[152:155], v[20:23], v[104:107], v[152:155]
    ds_read_b64_tr_b16 v[10:11], v246 offset:2048
    ds_read2st64_b32 v[160:161], v252 offset0:12 offset1:13
    v_mfma_f32_16x16x32_bf16 v[156:159], v[20:23], v[108:111], v[156:159]
    ds_read2st64_b32 v[164:165], v252 offset0:14 offset1:15
    v_mfma_f32_16x16x32_bf16 v[136:139], v[24:27], v[112:115], v[136:139]
    ds_read_b64_tr_b16 v[12:13], v247 offset:0
    ds_read2st64_b32 v[168:169], v252 offset0:16 offset1:17
    v_mfma_f32_16x16x32_bf16 v[140:143], v[24:27], v[116:119], v[140:143]
    ds_read_b64_tr_b16 v[14:15], v247 offset:2048
    ds_read2st64_b32 v[172:173], v252 offset0:18 offset1:19
    v_mfma_f32_16x16x32_bf16 v[144:147], v[24:27], v[120:123], v[144:147]
    ds_read2st64_b32 v[176:177], v252 offset0:20 offset1:21
    ds_read2st64_b32 v[180:181], v252 offset0:22 offset1:23
    v_mfma_f32_16x16x32_bf16 v[148:151], v[28:31], v[112:115], v[148:151]
    ds_read_b64_tr_b16 v[16:17], v246 offset:4096
    v_mfma_f32_16x16x32_bf16 v[152:155], v[28:31], v[116:119], v[152:155]
    ds_read_b64_tr_b16 v[18:19], v246 offset:6144
    v_mfma_f32_16x16x32_bf16 v[156:159], v[28:31], v[120:123], v[156:159]
    s_waitcnt lgkmcnt(12)
    v_mfma_f32_16x16x32_bf16 v[136:139], v[32:35], v[124:127], v[136:139]
    ds_read_b64_tr_b16 v[20:21], v247 offset:4096
    s_waitcnt lgkmcnt(7)
    v_mfma_f32_16x16x32_bf16 v[140:143], v[32:35], v[128:131], v[140:143]
    ds_read_b64_tr_b16 v[22:23], v247 offset:6144
    v_lshl_or_b32 v162, v160, 16, s13
    v_mfma_f32_16x16x32_bf16 v[144:147], v[32:35], v[132:135], v[144:147]
    v_lshl_or_b32 v163, v161, 16, s13
    v_lshl_or_b32 v166, v164, 16, s13
    v_mfma_f32_16x16x32_bf16 v[148:151], v[36:39], v[124:127], v[148:151]
    ds_read_b64_tr_b16 v[24:25], v246 offset:16384
    v_lshl_or_b32 v167, v165, 16, s13
    v_mfma_f32_16x16x32_bf16 v[152:155], v[36:39], v[128:131], v[152:155]
    ds_read_b64_tr_b16 v[26:27], v246 offset:18432
    v_lshl_or_b32 v170, v168, 16, s13
    v_mfma_f32_16x16x32_bf16 v[156:159], v[36:39], v[132:135], v[156:159]
    v_lshl_or_b32 v171, v169, 16, s13
    s_waitcnt lgkmcnt(9)
    v_mfma_f32_16x16x32_bf16 v[208:211], v[8:11], v[40:43], 0
    ds_read_b64_tr_b16 v[28:29], v247 offset:16384
    s_waitcnt lgkmcnt(7)
    v_lshl_or_b32 v174, v172, 16, s13
    v_mfma_f32_16x16x32_bf16 v[212:215], v[8:11], v[44:47], 0
    ds_read_b64_tr_b16 v[30:31], v247 offset:18432
    v_lshl_or_b32 v175, v173, 16, s13
    v_lshl_or_b32 v178, v176, 16, s13
    v_mfma_f32_16x16x32_bf16 v[216:219], v[8:11], v[48:51], 0
    v_lshl_or_b32 v179, v177, 16, s13
    v_lshl_or_b32 v182, v180, 16, s13
    v_mfma_f32_16x16x32_bf16 v[220:223], v[12:15], v[40:43], 0
    ds_read_b64_tr_b16 v[32:33], v246 offset:20480
    v_lshl_or_b32 v183, v181, 16, s13
    v_add_f32 v136, v136, v162
    v_mfma_f32_16x16x32_bf16 v[224:227], v[12:15], v[44:47], 0
    ds_read_b64_tr_b16 v[34:35], v246 offset:22528
    v_add_f32 v137, v137, v160
    v_add_f32 v138, v138, v163
    v_mfma_f32_16x16x32_bf16 v[228:231], v[12:15], v[48:51], 0
    v_add_f32 v139, v139, v161
    v_add_f32 v148, v148, v174
    s_waitcnt lgkmcnt(6)
    v_mfma_f32_16x16x32_bf16 v[208:211], v[16:19], v[52:55], v[208:211]
    ds_read_b64_tr_b16 v[36:37], v247 offset:20480
    v_add_f32 v149, v149, v172
    v_add_f32 v150, v150, v175
    v_mfma_f32_16x16x32_bf16 v[212:215], v[16:19], v[56:59], v[212:215]
    ds_read_b64_tr_b16 v[38:39], v247 offset:22528
    v_add_f32 v151, v151, v173
    v_perm_b32 v232, v137, v136, s12
    v_mfma_f32_16x16x32_bf16 v[216:219], v[16:19], v[60:63], v[216:219]
    v_perm_b32 v233, v139, v138, s12
    v_perm_b32 v234, v149, v148, s12
    v_mfma_f32_16x16x32_bf16 v[220:223], v[20:23], v[52:55], v[220:223]
    ds_read_b64_tr_b16 v[8:9], v246 offset:32768
    v_perm_b32 v235, v151, v150, s12
    v_bfi_b32 v232, s15, v248, v232
    v_mfma_f32_16x16x32_bf16 v[224:227], v[20:23], v[56:59], v[224:227]
    ds_read_b64_tr_b16 v[10:11], v246 offset:34816
    v_bfi_b32 v233, s15, v249, v233
    v_bfi_b32 v234, s15, v250, v234
    v_mfma_f32_16x16x32_bf16 v[228:231], v[20:23], v[60:63], v[228:231]
    v_bfi_b32 v235, s15, v251, v235
    buffer_store_dwordx4 v[232:235], v254, s[64:67], s10 offen offset:0 sc1
    s_waitcnt lgkmcnt(6)
    v_mfma_f32_16x16x32_bf16 v[208:211], v[24:27], v[64:67], v[208:211]
    ds_read_b64_tr_b16 v[12:13], v247 offset:32768
    v_add_f32 v140, v140, v166
    v_add_f32 v141, v141, v164
    v_mfma_f32_16x16x32_bf16 v[212:215], v[24:27], v[68:71], v[212:215]
    ds_read_b64_tr_b16 v[14:15], v247 offset:34816
    v_add_f32 v142, v142, v167
    v_add_f32 v143, v143, v165
    v_mfma_f32_16x16x32_bf16 v[216:219], v[24:27], v[72:75], v[216:219]
    v_add_f32 v152, v152, v178
    v_add_f32 v153, v153, v176
    v_mfma_f32_16x16x32_bf16 v[220:223], v[28:31], v[64:67], v[220:223]
    ds_read_b64_tr_b16 v[16:17], v246 offset:36864
    v_add_f32 v154, v154, v179
    v_add_f32 v155, v155, v177
    v_mfma_f32_16x16x32_bf16 v[224:227], v[28:31], v[68:71], v[224:227]
    ds_read_b64_tr_b16 v[18:19], v246 offset:38912
    v_perm_b32 v236, v141, v140, s12
    v_perm_b32 v237, v143, v142, s12
    v_mfma_f32_16x16x32_bf16 v[228:231], v[28:31], v[72:75], v[228:231]
    v_perm_b32 v238, v153, v152, s12
    v_perm_b32 v239, v155, v154, s12
    s_waitcnt lgkmcnt(6)
    v_mfma_f32_16x16x32_bf16 v[208:211], v[32:35], v[76:79], v[208:211]
    ds_read_b64_tr_b16 v[20:21], v247 offset:36864
    v_bfi_b32 v236, s15, v248, v236
    v_bfi_b32 v237, s15, v249, v237
    v_mfma_f32_16x16x32_bf16 v[212:215], v[32:35], v[80:83], v[212:215]
    ds_read_b64_tr_b16 v[22:23], v247 offset:38912
    v_bfi_b32 v238, s15, v250, v238
    v_bfi_b32 v239, s15, v251, v239
    v_mfma_f32_16x16x32_bf16 v[216:219], v[32:35], v[84:87], v[216:219]
    buffer_store_dwordx4 v[236:239], v254, s[64:67], s10 offen offset:1024 sc1
    v_add_f32 v144, v144, v170
    v_mfma_f32_16x16x32_bf16 v[220:223], v[36:39], v[76:79], v[220:223]
    ds_read_b64_tr_b16 v[24:25], v246 offset:49152
    v_add_f32 v145, v145, v168
    v_add_f32 v146, v146, v171
    v_mfma_f32_16x16x32_bf16 v[224:227], v[36:39], v[80:83], v[224:227]
    ds_read_b64_tr_b16 v[26:27], v246 offset:51200
    v_add_f32 v147, v147, v169
    v_add_f32 v156, v156, v182
    v_mfma_f32_16x16x32_bf16 v[228:231], v[36:39], v[84:87], v[228:231]
    v_add_f32 v157, v157, v180
    v_add_f32 v158, v158, v183
    s_waitcnt lgkmcnt(6)
    v_mfma_f32_16x16x32_bf16 v[208:211], v[8:11], v[88:91], v[208:211]
    ds_read_b64_tr_b16 v[28:29], v247 offset:49152
    v_add_f32 v159, v159, v181
    v_perm_b32 v240, v145, v144, s12
    v_mfma_f32_16x16x32_bf16 v[212:215], v[8:11], v[92:95], v[212:215]
    ds_read_b64_tr_b16 v[30:31], v247 offset:51200
    v_perm_b32 v241, v147, v146, s12
    v_perm_b32 v242, v157, v156, s12
    v_mfma_f32_16x16x32_bf16 v[216:219], v[8:11], v[96:99], v[216:219]
    v_perm_b32 v243, v159, v158, s12
    v_bfi_b32 v240, s15, v248, v240
    v_mfma_f32_16x16x32_bf16 v[220:223], v[12:15], v[88:91], v[220:223]
    ds_read_b64_tr_b16 v[32:33], v246 offset:53248
    v_bfi_b32 v241, s15, v249, v241
    v_bfi_b32 v242, s15, v250, v242
    v_mfma_f32_16x16x32_bf16 v[224:227], v[12:15], v[92:95], v[224:227]
    ds_read_b64_tr_b16 v[34:35], v246 offset:55296
    v_bfi_b32 v243, s15, v251, v243
    buffer_store_dwordx4 v[240:243], v254, s[64:67], s10 offen offset:2048 sc1
    v_mfma_f32_16x16x32_bf16 v[228:231], v[12:15], v[96:99], v[228:231]
    s_add_u32 s10, s10, 16384
    s_waitcnt lgkmcnt(6)
    v_mfma_f32_16x16x32_bf16 v[208:211], v[16:19], v[100:103], v[208:211]
    ds_read_b64_tr_b16 v[36:37], v247 offset:53248
    v_mfma_f32_16x16x32_bf16 v[212:215], v[16:19], v[104:107], v[212:215]
    ds_read_b64_tr_b16 v[38:39], v247 offset:55296
    v_mfma_f32_16x16x32_bf16 v[216:219], v[16:19], v[108:111], v[216:219]
    v_mfma_f32_16x16x32_bf16 v[220:223], v[20:23], v[100:103], v[220:223]
    ds_read_b64_tr_b16 v[8:9], v244 offset:0
    v_mfma_f32_16x16x32_bf16 v[224:227], v[20:23], v[104:107], v[224:227]
    ds_read_b64_tr_b16 v[10:11], v244 offset:2048
    v_mfma_f32_16x16x32_bf16 v[228:231], v[20:23], v[108:111], v[228:231]
    s_waitcnt lgkmcnt(6)
    v_mfma_f32_16x16x32_bf16 v[208:211], v[24:27], v[112:115], v[208:211]
    ds_read_b64_tr_b16 v[12:13], v245 offset:0
    v_mfma_f32_16x16x32_bf16 v[212:215], v[24:27], v[116:119], v[212:215]
    ds_read_b64_tr_b16 v[14:15], v245 offset:2048
    v_mfma_f32_16x16x32_bf16 v[216:219], v[24:27], v[120:123], v[216:219]
    v_mfma_f32_16x16x32_bf16 v[220:223], v[28:31], v[112:115], v[220:223]
    ds_read_b64_tr_b16 v[16:17], v244 offset:4096
    v_mfma_f32_16x16x32_bf16 v[224:227], v[28:31], v[116:119], v[224:227]
    ds_read_b64_tr_b16 v[18:19], v244 offset:6144
    v_mfma_f32_16x16x32_bf16 v[228:231], v[28:31], v[120:123], v[228:231]
    s_waitcnt lgkmcnt(6)
    v_mfma_f32_16x16x32_bf16 v[208:211], v[32:35], v[124:127], v[208:211]
    ds_read_b64_tr_b16 v[20:21], v245 offset:4096
    v_mfma_f32_16x16x32_bf16 v[212:215], v[32:35], v[128:131], v[212:215]
    ds_read_b64_tr_b16 v[22:23], v245 offset:6144
    v_mfma_f32_16x16x32_bf16 v[216:219], v[32:35], v[132:135], v[216:219]
    v_mfma_f32_16x16x32_bf16 v[220:223], v[36:39], v[124:127], v[220:223]
    ds_read_b64_tr_b16 v[24:25], v244 offset:16384
    v_mfma_f32_16x16x32_bf16 v[224:227], v[36:39], v[128:131], v[224:227]
    ds_read_b64_tr_b16 v[26:27], v244 offset:18432
    v_mfma_f32_16x16x32_bf16 v[228:231], v[36:39], v[132:135], v[228:231]
    s_waitcnt lgkmcnt(6)
    v_mfma_f32_16x16x32_bf16 v[184:187], v[8:11], v[40:43], 0
    ds_read_b64_tr_b16 v[28:29], v245 offset:16384
    v_cvt_pk_bf16_f32 v208, v208, v209
    v_mfma_f32_16x16x32_bf16 v[188:191], v[8:11], v[44:47], 0
    ds_read_b64_tr_b16 v[30:31], v245 offset:18432
    v_cvt_pk_bf16_f32 v209, v210, v211
    v_mfma_f32_16x16x32_bf16 v[192:195], v[8:11], v[48:51], 0
    v_cvt_pk_bf16_f32 v212, v212, v213
    v_cvt_pk_bf16_f32 v213, v214, v215
    v_mfma_f32_16x16x32_bf16 v[196:199], v[12:15], v[40:43], 0
    ds_read_b64_tr_b16 v[32:33], v244 offset:20480
    v_cvt_pk_bf16_f32 v216, v216, v217
    v_mfma_f32_16x16x32_bf16 v[200:203], v[12:15], v[44:47], 0
    ds_read_b64_tr_b16 v[34:35], v244 offset:22528
    v_cvt_pk_bf16_f32 v217, v218, v219
    v_mfma_f32_16x16x32_bf16 v[204:207], v[12:15], v[48:51], 0
    v_cvt_pk_bf16_f32 v220, v220, v221
    s_waitcnt lgkmcnt(6)
    v_mfma_f32_16x16x32_bf16 v[184:187], v[16:19], v[52:55], v[184:187]
    ds_read_b64_tr_b16 v[36:37], v245 offset:20480
    v_cvt_pk_bf16_f32 v221, v222, v223
    v_mfma_f32_16x16x32_bf16 v[188:191], v[16:19], v[56:59], v[188:191]
    ds_read_b64_tr_b16 v[38:39], v245 offset:22528
    v_cvt_pk_bf16_f32 v224, v224, v225
    v_mfma_f32_16x16x32_bf16 v[192:195], v[16:19], v[60:63], v[192:195]
    v_cvt_pk_bf16_f32 v225, v226, v227
    v_cvt_pk_bf16_f32 v228, v228, v229
    v_mfma_f32_16x16x32_bf16 v[196:199], v[20:23], v[52:55], v[196:199]
    ds_read_b64_tr_b16 v[8:9], v244 offset:32768
    v_cvt_pk_bf16_f32 v229, v230, v231
    v_mfma_f32_16x16x32_bf16 v[200:203], v[20:23], v[56:59], v[200:203]
    ds_read_b64_tr_b16 v[10:11], v244 offset:34816
    ds_write_addtid_b32 v208 offset:57344
    v_mfma_f32_16x16x32_bf16 v[204:207], v[20:23], v[60:63], v[204:207]
    ds_write_addtid_b32 v209 offset:57600
    s_waitcnt lgkmcnt(8)
    v_mfma_f32_16x16x32_bf16 v[184:187], v[24:27], v[64:67], v[184:187]
    ds_read_b64_tr_b16 v[12:13], v244 offset:36864
    ds_write_addtid_b32 v212 offset:57856
    v_mfma_f32_16x16x32_bf16 v[188:191], v[24:27], v[68:71], v[188:191]
    ds_read_b64_tr_b16 v[14:15], v244 offset:38912
    ds_write_addtid_b32 v213 offset:58112
    v_mfma_f32_16x16x32_bf16 v[192:195], v[24:27], v[72:75], v[192:195]
    ds_write_addtid_b32 v216 offset:58368
    ds_write_addtid_b32 v217 offset:58624
    v_mfma_f32_16x16x32_bf16 v[196:199], v[28:31], v[64:67], v[196:199]
    ds_read_b64_tr_b16 v[16:17], v244 offset:49152
    ds_write_addtid_b32 v220 offset:58880
    v_mfma_f32_16x16x32_bf16 v[200:203], v[28:31], v[68:71], v[200:203]
    ds_read_b64_tr_b16 v[18:19], v244 offset:51200
    ds_write_addtid_b32 v221 offset:59136
    v_mfma_f32_16x16x32_bf16 v[204:207], v[28:31], v[72:75], v[204:207]
    ds_write_addtid_b32 v224 offset:59392
    s_waitcnt lgkmcnt(15)
    v_mfma_f32_16x16x32_bf16 v[184:187], v[32:35], v[76:79], v[184:187]
    ds_read_b64_tr_b16 v[20:21], v244 offset:53248
    ds_write_addtid_b32 v225 offset:59648
    v_mfma_f32_16x16x32_bf16 v[188:191], v[32:35], v[80:83], v[188:191]
    ds_read_b64_tr_b16 v[22:23], v244 offset:55296
    ds_write_addtid_b32 v228 offset:59904
    v_mfma_f32_16x16x32_bf16 v[192:195], v[32:35], v[84:87], v[192:195]
    ds_write_addtid_b32 v229 offset:60160
    v_mfma_f32_16x16x32_bf16 v[196:199], v[36:39], v[76:79], v[196:199]
    ds_read_b64_tr_b16 v[24:25], v245 offset:32768
    v_mfma_f32_16x16x32_bf16 v[200:203], v[36:39], v[80:83], v[200:203]
    ds_read_b64_tr_b16 v[26:27], v245 offset:34816
    v_mfma_f32_16x16x32_bf16 v[204:207], v[36:39], v[84:87], v[204:207]
    s_waitcnt lgkmcnt(15)
    v_mfma_f32_16x16x32_bf16 v[184:187], v[8:11], v[88:91], v[184:187]
    ds_read_b64_tr_b16 v[28:29], v245 offset:36864
    v_mfma_f32_16x16x32_bf16 v[188:191], v[8:11], v[92:95], v[188:191]
    ds_read_b64_tr_b16 v[30:31], v245 offset:38912
    v_mfma_f32_16x16x32_bf16 v[192:195], v[8:11], v[96:99], v[192:195]
    v_mfma_f32_16x16x32_bf16 v[184:187], v[12:15], v[100:103], v[184:187]
    ds_read_b64_tr_b16 v[32:33], v245 offset:49152
    v_mfma_f32_16x16x32_bf16 v[188:191], v[12:15], v[104:107], v[188:191]
    ds_read_b64_tr_b16 v[34:35], v245 offset:51200
    v_mfma_f32_16x16x32_bf16 v[192:195], v[12:15], v[108:111], v[192:195]
    s_waitcnt lgkmcnt(8)
    v_mfma_f32_16x16x32_bf16 v[184:187], v[16:19], v[112:115], v[184:187]
    ds_read_b64_tr_b16 v[36:37], v245 offset:53248
    v_mfma_f32_16x16x32_bf16 v[188:191], v[16:19], v[116:119], v[188:191]
    ds_read_b64_tr_b16 v[38:39], v245 offset:55296
    v_mfma_f32_16x16x32_bf16 v[192:195], v[16:19], v[120:123], v[192:195]
    v_mfma_f32_16x16x32_bf16 v[184:187], v[20:23], v[124:127], v[184:187]
    v_mfma_f32_16x16x32_bf16 v[188:191], v[20:23], v[128:131], v[188:191]
    v_mfma_f32_16x16x32_bf16 v[192:195], v[20:23], v[132:135], v[192:195]
    s_waitcnt lgkmcnt(4)
    v_mfma_f32_16x16x32_bf16 v[196:199], v[24:27], v[88:91], v[196:199]
    v_mfma_f32_16x16x32_bf16 v[200:203], v[24:27], v[92:95], v[200:203]
    v_mfma_f32_16x16x32_bf16 v[204:207], v[24:27], v[96:99], v[204:207]
    v_mfma_f32_16x16x32_bf16 v[196:199], v[28:31], v[100:103], v[196:199]
    s_nop 0
    ds_write_b128 v253, v[184:187] offset:0
    ds_write_b128 v253, v[188:191] offset:1024
    v_mfma_f32_16x16x32_bf16 v[200:203], v[28:31], v[104:107], v[200:203]
    ds_write_b128 v253, v[192:195] offset:2048
    v_mfma_f32_16x16x32_bf16 v[204:207], v[28:31], v[108:111], v[204:207]
    s_waitcnt lgkmcnt(3)
    v_mfma_f32_16x16x32_bf16 v[196:199], v[32:35], v[112:115], v[196:199]
    v_mfma_f32_16x16x32_bf16 v[200:203], v[32:35], v[116:119], v[200:203]
    v_mfma_f32_16x16x32_bf16 v[204:207], v[32:35], v[120:123], v[204:207]
    v_mfma_f32_16x16x32_bf16 v[196:199], v[36:39], v[124:127], v[196:199]
    v_mfma_f32_16x16x32_bf16 v[200:203], v[36:39], v[128:131], v[200:203]
    v_mfma_f32_16x16x32_bf16 v[204:207], v[36:39], v[132:135], v[204:207]
    s_nop 5
    ds_write_b128 v253, v[196:199] offset:3072
    ds_write_b128 v253, v[200:203] offset:4096
    ds_write_b128 v253, v[204:207] offset:5120
    s_waitcnt lgkmcnt(0)
    s_barrier
    s_endpgm
L_cns:
    v_mov_b32 v5, 0
    buffer_load_dwordx2 v[6:7], v5, s[24:27], s21 offen sc1
    s_sub_u32 s37, s37, 1
    s_cbranch_scc1 L_end
    s_waitcnt vmcnt(0)
    v_readfirstlane_b32 s22, v6
    v_readfirstlane_b32 s23, v7
    s_nop 0
    s_cmp_eq_u32 s23, 0
    s_cbranch_scc1 L_cns
    s_branch L_cnb
L_end:
    s_endpgm
.section .rodata,"a"
.p2align 6
.amdhsa_kernel concat_heads__mha_block_cached__gqa_block_cached__near_ridge_kernel
  .amdhsa_next_free_vgpr 256
  .amdhsa_next_free_sgpr 100
  .amdhsa_accum_offset 256
  .amdhsa_group_segment_fixed_size 0
  .amdhsa_kernarg_size 104
  .amdhsa_user_sgpr_count 2
  .amdhsa_user_sgpr_kernarg_segment_ptr 1
  .amdhsa_system_sgpr_workgroup_id_x 1
.end_amdhsa_kernel
```
